```python
import torch

def _softmax(x, axis=-1):
    return torch.softmax(x, dim=axis)
def _gelu(x):
    return torch.nn.functional.gelu(x, approximate="tanh")
def _silu(x):
    return torch.nn.functional.silu(x)
def _sigmoid(x):
    return torch.sigmoid(x)
def _layernorm(x, axis=-1, eps=1e-5):
    m = x.mean(dim=axis, keepdim=True)
    v = x.var(dim=axis, keepdim=True, unbiased=False)
    return (x - m) / torch.sqrt(v + eps)
def _scatter_add(tgt, idx, src, axis=0):
    return tgt.clone().index_add_(axis, idx, src)
def _segment_sum(src, seg, n):
    out = torch.zeros((n,) + src.shape[1:], dtype=src.dtype)
    return out.index_add_(0, seg, src)
def _pad(x, pw):
    flat = tuple(v for pair in reversed(pw) for v in pair)
    return torch.nn.functional.pad(x, flat)

kernel_name = 'standalone__global_local_windowed_global_tokens__prompt'

def setup_inputs():

    _w = (lambda a: (lambda t: t.to(torch.bfloat16) if t.is_floating_point() else t)(torch.as_tensor(a)))
    B, H, S, D = 1, 32, 2048, 192
    return {
        "q": _w((lambda *s: torch.randn(*s, dtype=torch.bfloat16) * 0.8)(B, H, S, D)),
        "k": _w((lambda *s: torch.randn(*s, dtype=torch.bfloat16) * 0.8)(B, H, S, D)),
        "v": _w((lambda *s: torch.randn(*s, dtype=torch.bfloat16) * 0.05)(B, H, S, D)),
        "window": 32,
        "n_global": 2,
    }

def reference(q, k, v, window, n_global):
    B, H, S, D = q.shape
    scale = D ** -0.5
    scores = torch.einsum("bhqd,bhkd->bhqk", q, k) * scale
    idx = torch.arange(S)
    dist = idx[:, None] - idx[None, :]
    local = (dist <= window) & (dist >= -window)
    is_global_q = (idx < n_global)[:, None]
    is_global_k = (idx < n_global)[None, :]
    mask = local | is_global_q | is_global_k
    scores = torch.where(mask[None, None], scores, -1e9)
    p = _softmax(scores, axis=-1)
    return torch.einsum("bhqk,bhkd->bhqd", p, v)
```

```asm
; @launch grid=(256,1,1) block=(256,1,1) lds=160768
.amdgcn_target "amdgcn-amd-amdhsa--gfx950"
.text
.globl standalone__global_local_windowed_global_tokens__prompt_kernel
.p2align 8
.type standalone__global_local_windowed_global_tokens__prompt_kernel,@function
standalone__global_local_windowed_global_tokens__prompt_kernel:
    s_cmpk_ge_u32 s2, 256
    s_cbranch_scc1 L_end
    s_load_dwordx16 s[76:91], s[0:1], 0
    v_lshrrev_b32 v1, 6, v0
    v_and_b32 v0, 63, v0
    v_readfirstlane_b32 s3, v1
    v_lshrrev_b32 v36, 3, v0
    v_and_b32 v37, 7, v0
    v_xor_b32 v38, v36, v37
    v_mul_u32_u24 v36, 384, v36
    v_lshl_add_u32 v2, v38, 4, v36
    s_and_b32 s40, s2, 7
    s_lshr_b32 s44, s2, 6
    s_lshl2_add_u32 s40, s40, s44
    s_lshr_b32 s41, s2, 3
    s_and_b32 s41, s41, 7
    s_mul_i32 s45, s40, 786432
    s_lshl_b32 s46, s41, 5
    s_add_u32 s46, s46, s3
    s_sub_i32 s46, s46, 4
    s_mulk_i32 s46, 3072
    s_mul_i32 s47, s3, 3072
    s_mov_b32 s11, 0x20000
    s_movk_i32 s51, 896
    s_getpc_b64 s[62:63]
    s_lshr_b32 s50, s2, 3
    s_lshl2_add_u32 s50, s50, s3
    s_lshl_b32 s50, s50, 7
    s_min_u32 s50, s50, 11912
    v_mov_b32 v46, s50
    global_load_dword v47, v46, s[62:63]
    s_add_u32 m0, s47, 0
    s_add_i32 s44, s46, 0
    s_max_i32 s44, s44, 0
    s_cmp_eq_u32 s41, 0
    s_cselect_b32 s10, 0, 786432
    s_waitcnt lgkmcnt(0)
    s_add_u32 s8, s78, s45
    s_addc_u32 s9, s79, 0
    buffer_load_dwordx4 v2, s[8:11], s44 offen offset:0 nt lds
    s_add_u32 m0, m0, s51
    s_nop 0
    buffer_load_dwordx4 v2, s[8:11], s44 offen offset:128 nt lds
    s_add_u32 m0, m0, s51
    s_nop 0
    buffer_load_dwordx4 v2, s[8:11], s44 offen offset:256 nt lds
    s_mov_b32 s10, 786432
    s_add_u32 m0, s47, 98304
    s_add_i32 s44, s46, 98304
    buffer_load_dwordx4 v2, s[8:11], s44 offen offset:0 nt lds
    s_add_u32 m0, m0, s51
    s_nop 0
    buffer_load_dwordx4 v2, s[8:11], s44 offen offset:128 nt lds
    s_add_u32 m0, m0, s51
    s_nop 0
    buffer_load_dwordx4 v2, s[8:11], s44 offen offset:256 nt lds
    v_lshl_add_u32 v248, v37, 4, v36
    v_lshlrev_b32 v1, 4, v0
    s_lshl2_add_u32 s60, s41, s3
    s_mul_i32 s42, s60, 24576
    s_lshl_b32 s60, s60, 6
    s_mul_i32 s43, s3, 9216
    s_add_u32 s43, s43, 122880
    s_mov_b32 s6, 786432
    s_mov_b32 s7, 0x20000
    s_mov_b32 s14, 786432
    s_mov_b32 s15, 0x20000
    s_add_u32 m0, s47, 12288
    s_add_i32 s44, s46, 12288
    buffer_load_dwordx4 v2, s[8:11], s44 offen offset:0 nt lds
    s_add_u32 m0, m0, s51
    s_nop 0
    buffer_load_dwordx4 v2, s[8:11], s44 offen offset:128 nt lds
    s_add_u32 m0, m0, s51
    s_nop 0
    buffer_load_dwordx4 v2, s[8:11], s44 offen offset:256 nt lds
    s_add_u32 m0, s47, 110592
    s_add_i32 s44, s46, 110592
    s_min_i32 s44, s44, 783360
    s_cmp_eq_u32 s41, 7
    s_cselect_b32 s10, 0, 786432
    s_waitcnt vmcnt(8)
    buffer_load_dwordx4 v2, s[8:11], s44 offen offset:0 nt lds
    s_add_u32 m0, m0, s51
    s_waitcnt vmcnt(8)
    buffer_load_dwordx4 v2, s[8:11], s44 offen offset:128 nt lds
    s_add_u32 m0, m0, s51
    s_waitcnt vmcnt(8)
    buffer_load_dwordx4 v2, s[8:11], s44 offen offset:256 nt lds
    s_mov_b32 s10, 786432
    s_add_u32 s4, s76, s45
    s_addc_u32 s5, s77, 0
    s_add_u32 s12, s80, s45
    s_addc_u32 s13, s81, 0
    s_mov_b64 s[16:17], s[86:87]
    s_mov_b64 s[24:25], s[88:89]
    s_mov_b64 s[20:21], s[90:91]
    s_add_u32 m0, s43, 6144
    s_waitcnt vmcnt(8)
    buffer_load_dwordx4 v1, s[8:11], 0 offen  lds
    s_add_u32 m0, s43, 7168
    s_waitcnt vmcnt(8)
    buffer_load_dwordx4 v1, s[4:7], 0 offen  lds
    s_add_u32 m0, s43, 8192
    s_waitcnt vmcnt(8)
    buffer_load_dwordx4 v1, s[12:15], 0 offen  lds
    v_and_b32 v33, 15, v0
    v_lshrrev_b32 v36, 4, v0
    v_and_b32 v37, 7, v33
    v_mul_u32_u24 v37, 384, v37
    v_lshl_add_u32 v37, v36, 4, v37
    v_and_b32 v15, 8, v33
    v_lshl_add_u32 v14, v15, 3, v37
    v_xor_b32 v15, 64, v14
    v_add_u32 v15, 3072, v15
    v_lshrrev_b32 v37, 3, v0
    v_and_b32 v37, 6, v37
    v_lshlrev_b32 v37, 4, v37
    v_xor_b32 v21, v37, v248
    v_lshrrev_b32 v37, 3, v33
    v_mul_u32_u24 v38, 3072, v37
    v_and_b32 v37, 7, v33
    v_lshl_add_u32 v38, v37, 7, v38
    v_xor_b32 v37, v37, v36
    v_lshl_add_u32 v38, v37, 4, v38
    s_add_u32 m0, s47, 24576
    s_add_i32 s44, s46, 24576
    s_waitcnt vmcnt(8)
    buffer_load_dwordx4 v2, s[8:11], s44 offen offset:0 nt lds
    s_add_u32 m0, m0, s51
    s_waitcnt vmcnt(8)
    buffer_load_dwordx4 v2, s[8:11], s44 offen offset:128 nt lds
    s_add_u32 m0, m0, s51
    s_waitcnt vmcnt(8)
    buffer_load_dwordx4 v2, s[8:11], s44 offen offset:256 nt lds
    s_mul_i32 s50, s3, 24576
    v_add_u32 v7, s50, v38
    v_xor_b32 v8, 64, v7
    v_and_b32 v37, 1, v33
    v_mul_u32_u24 v37, 384, v37
    v_lshl_add_u32 v37, v36, 4, v37
    v_add_u32 v24, s43, v37
    v_lshrrev_b32 v36, 4, v0
    v_lshlrev_b32 v34, 2, v36
    v_mov_b32 v35, 0xf1000000
    v_lshlrev_b32 v38, 7, v33
    v_and_b32 v37, 1, v36
    v_lshl_add_u32 v38, v37, 3, v38
    v_add_u32 v38, s43, v38
    v_lshrrev_b32 v39, 1, v36
    v_and_b32 v37, 7, v33
    v_xor_b32 v39, v39, v37
    v_xor_b32 v37, 0, v39
    v_lshl_add_u32 v9, v37, 4, v38
    s_add_u32 m0, s47, 36864
    s_add_i32 s44, s46, 36864
    s_waitcnt vmcnt(8)
    buffer_load_dwordx4 v2, s[8:11], s44 offen offset:0 nt lds
    s_add_u32 m0, m0, s51
    s_waitcnt vmcnt(8)
    buffer_load_dwordx4 v2, s[8:11], s44 offen offset:128 nt lds
    s_add_u32 m0, m0, s51
    s_waitcnt vmcnt(8)
    buffer_load_dwordx4 v2, s[8:11], s44 offen offset:256 nt lds
    v_xor_b32 v37, 2, v39
    v_lshl_add_u32 v10, v37, 4, v38
    v_xor_b32 v37, 4, v39
    v_lshl_add_u32 v11, v37, 4, v38
    v_xor_b32 v37, 6, v39
    v_lshl_add_u32 v12, v37, 4, v38
    v_lshrrev_b32 v37, 3, v0
    v_and_b32 v38, 7, v0
    v_xor_b32 v39, v37, v38
    v_lshlrev_b32 v39, 4, v39
    v_lshl_add_u32 v39, v37, 7, v39
    v_add_u32 v13, s43, v39
    v_and_b32 v39, 3, v0
    v_bfe_u32 v37, v0, 2, 3
    v_lshlrev_b32 v38, 7, v37
    v_lshrrev_b32 v37, 5, v0
    v_mul_u32_u24 v37, 3072, v37
    v_add_u32 v38, v38, v37
    v_lshl_add_u32 v38, v39, 3, v38
    s_add_u32 m0, s47, 49152
    s_add_i32 s44, s46, 49152
    s_waitcnt vmcnt(8)
    buffer_load_dwordx4 v2, s[8:11], s44 offen offset:0 nt lds
    s_add_u32 m0, m0, s51
    s_waitcnt vmcnt(8)
    buffer_load_dwordx4 v2, s[8:11], s44 offen offset:128 nt lds
    s_add_u32 m0, m0, s51
    s_waitcnt vmcnt(8)
    buffer_load_dwordx4 v2, s[8:11], s44 offen offset:256 nt lds
    v_bfe_u32 v40, v0, 3, 2
    s_mul_i32 s48, s3, 24576
    v_xor_b32 v37, 0, v40
    v_lshl_add_u32 v37, v37, 5, v38
    v_add_u32 v16, s48, v37
    v_xor_b32 v37, 1, v40
    v_lshl_add_u32 v37, v37, 5, v38
    v_add_u32 v17, s48, v37
    v_xor_b32 v37, 2, v40
    v_lshl_add_u32 v37, v37, 5, v38
    v_add_u32 v18, s48, v37
    v_xor_b32 v37, 3, v40
    v_lshl_add_u32 v37, v37, 5, v38
    v_add_u32 v19, s48, v37
    v_xor_b32 v37, s3, v40
    v_lshl_add_u32 v37, v37, 5, v38
    v_add_u32 v25, 12288, v37
    v_add_u32 v26, 61440, v37
    v_bfe_u32 v37, v0, 2, 1
    s_add_u32 m0, s47, 61440
    s_add_i32 s44, s46, 61440
    s_waitcnt vmcnt(8)
    buffer_load_dwordx4 v2, s[8:11], s44 offen offset:0 nt lds
    s_add_u32 m0, m0, s51
    s_waitcnt vmcnt(8)
    buffer_load_dwordx4 v2, s[8:11], s44 offen offset:128 nt lds
    s_add_u32 m0, m0, s51
    s_waitcnt vmcnt(8)
    buffer_load_dwordx4 v2, s[8:11], s44 offen offset:256 nt lds
    v_mul_u32_u24 v37, 384, v37
    v_lshl_add_u32 v37, v39, 3, v37
    v_add_u32 v20, s43, v37
    v_add_u32 v28, s43, v1
    v_add_u32 v29, 129024, v1
    v_lshlrev_b32 v37, 4, v33
    v_add_u32 v30, 159744, v37
    s_mul_i32 s48, s41, 1536
    s_lshl_b32 s50, s3, 6
    s_add_u32 s48, s48, s50
    v_cmp_gt_u32 vcc, 2, v33
    v_mul_u32_u24 v37, 768, v33
    v_lshl_add_u32 v37, v36, 4, v37
    v_add_u32 v37, s48, v37
    v_cndmask_b32 v31, v35, v37, vcc
    s_cmp_eq_u32 s3, 0
    s_cselect_b32 s50, 2, 0
    v_cmp_gt_u32 vcc, s50, v0
    s_lshl_b32 s48, s41, 3
    s_add_u32 m0, s47, 73728
    s_add_i32 s44, s46, 73728
    s_waitcnt vmcnt(8)
    buffer_load_dwordx4 v2, s[8:11], s44 offen offset:0 nt lds
    s_add_u32 m0, m0, s51
    s_waitcnt vmcnt(8)
    buffer_load_dwordx4 v2, s[8:11], s44 offen offset:128 nt lds
    s_add_u32 m0, m0, s51
    s_waitcnt vmcnt(8)
    buffer_load_dwordx4 v2, s[8:11], s44 offen offset:256 nt lds
    s_add_u32 s48, s48, 12288
    v_lshlrev_b32 v37, 6, v33
    v_add_u32 v37, s48, v37
    v_cndmask_b32 v32, v35, v37, vcc
    s_cmp_eq_u32 s60, 0
    s_cselect_b32 s48, 16, 0
    v_cmp_gt_u32 vcc, s48, v0
    s_mov_b32 s49, 0x3dd53b95
    s_add_u32 s16, s16, s45
    s_addc_u32 s17, s17, 0
    v_cndmask_b32 v249, v248, v35, vcc
    v_cmp_gt_u32 vcc, 16, v0
    s_mov_b32 s18, 786432
    s_mov_b32 s19, 0x20000
    v_cndmask_b32 v68, v35, 0, vcc
    v_cndmask_b32 v3, 0, v35, vcc
    v_mov_b32 v70, v35
    v_mov_b32 v69, v68
    v_mov_b32 v71, v35
    s_add_u32 m0, s47, 86016
    s_add_i32 s44, s46, 86016
    s_waitcnt vmcnt(8)
    buffer_load_dwordx4 v2, s[8:11], s44 offen offset:0 nt lds
    s_add_u32 m0, m0, s51
    s_waitcnt vmcnt(8)
    buffer_load_dwordx4 v2, s[8:11], s44 offen offset:128 nt lds
    s_add_u32 m0, m0, s51
    s_waitcnt vmcnt(8)
    buffer_load_dwordx4 v2, s[8:11], s44 offen offset:256 nt lds
    v_add_u32 v40, 0, v34
    v_add_u32 v41, 1, v34
    v_add_u32 v42, 2, v34
    v_add_u32 v43, 3, v34
    v_cmp_lt_u32 s[52:53], v40, v33
    v_cmp_lt_u32 s[54:55], v41, v33
    v_cmp_lt_u32 s[56:57], v42, v33
    v_cmp_lt_u32 s[58:59], v43, v33
    v_cndmask_b32 v48, 0, v35, s[52:53]
    v_cndmask_b32 v49, 0, v35, s[54:55]
    v_cndmask_b32 v50, 0, v35, s[56:57]
    v_cndmask_b32 v51, 0, v35, s[58:59]
    v_cmp_gt_u32 s[52:53], v40, v33
    v_cmp_gt_u32 s[54:55], v41, v33
    v_cmp_gt_u32 s[56:57], v42, v33
    v_cmp_gt_u32 s[58:59], v43, v33
    v_cndmask_b32 v64, 0, v35, s[52:53]
    v_cndmask_b32 v65, 0, v35, s[54:55]
    v_cndmask_b32 v66, 0, v35, s[56:57]
    s_add_i32 s44, s42, 0
    s_waitcnt vmcnt(8)
    buffer_load_dwordx4 v[192:195], v14, s[4:7], s44 offen offset:0 nt
    s_waitcnt vmcnt(8)
    buffer_load_dwordx4 v[196:199], v15, s[4:7], s44 offen offset:0 nt
    s_waitcnt vmcnt(8)
    buffer_load_dwordx4 v[200:203], v14, s[4:7], s44 offen offset:128 nt
    s_waitcnt vmcnt(8)
    buffer_load_dwordx4 v[204:207], v15, s[4:7], s44 offen offset:128 nt
    s_waitcnt vmcnt(8)
    buffer_load_dwordx4 v[208:211], v14, s[4:7], s44 offen offset:256 nt
    s_waitcnt vmcnt(8)
    buffer_load_dwordx4 v[212:215], v15, s[4:7], s44 offen offset:256 nt
    v_cndmask_b32 v67, 0, v35, s[58:59]
    v_mov_b32 v52, 0
    v_mov_b32 v53, 0
    v_mov_b32 v54, 0
    v_mov_b32 v55, 0
    v_mov_b32 v56, 0
    v_mov_b32 v57, 0
    v_mov_b32 v58, 0
    v_mov_b32 v59, 0
    v_mov_b32 v60, 0
    v_mov_b32 v61, 0
    v_mov_b32 v62, 0
    v_mov_b32 v63, 0
    s_lshl_b32 s48, s40, 14
    s_add_u32 s20, s20, s48
    s_addc_u32 s21, s21, 0
    s_mov_b32 s22, 16384
    s_mov_b32 s23, 0x20000
    s_mov_b32 s26, 256
    s_mov_b32 s27, 0x20000
    s_add_i32 s44, s42, 6144
    s_waitcnt vmcnt(8)
    buffer_load_dwordx4 v[220:223], v14, s[4:7], s44 offen offset:0 nt
    s_waitcnt vmcnt(8)
    buffer_load_dwordx4 v[224:227], v15, s[4:7], s44 offen offset:0 nt
    s_waitcnt vmcnt(8)
    buffer_load_dwordx4 v[228:231], v14, s[4:7], s44 offen offset:128 nt
    s_waitcnt vmcnt(8)
    buffer_load_dwordx4 v[232:235], v15, s[4:7], s44 offen offset:128 nt
    s_waitcnt vmcnt(8)
    buffer_load_dwordx4 v[236:239], v14, s[4:7], s44 offen offset:256 nt
    s_waitcnt vmcnt(8)
    buffer_load_dwordx4 v[240:243], v15, s[4:7], s44 offen offset:256 nt
    s_cmp_lg_u32 s60, 0
    s_cbranch_scc1 L_noleft0
    v_mov_b32 v4, v48
    v_mov_b32 v5, v49
    v_mov_b32 v6, v50
    v_mov_b32 v190, v51
    v_mov_b32 v48, v35
    v_mov_b32 v49, v35
    v_mov_b32 v50, v35
    v_mov_b32 v51, v35
    v_mov_b32 v52, v35
    v_mov_b32 v53, v35
    v_mov_b32 v54, v35
    v_mov_b32 v55, v35
    v_mov_b32 v56, v3
    v_mov_b32 v57, v3
L_noleft0:
    ds_read_b128 v[144:147], v24 offset:7168
    ds_read_b128 v[148:151], v24 offset:7232
    ds_read_b128 v[152:155], v24 offset:7296
    ds_read_b128 v[156:159], v24 offset:7360
    ds_read_b128 v[160:163], v24 offset:7424
    ds_read_b128 v[164:167], v24 offset:7488
    ds_read_b128 a[192:195], v24 offset:6144
    ds_read_b128 a[196:199], v24 offset:6208
    ds_read_b128 a[200:203], v24 offset:6272
    ds_read_b128 a[204:207], v24 offset:6336
    ds_read_b128 a[208:211], v24 offset:6400
    ds_read_b128 a[212:215], v24 offset:6464
    s_barrier
    ds_read_b128 a[48:51], v7 offset:12288
    ds_read_b128 a[52:55], v8 offset:12288
    ds_read_b128 a[56:59], v7 offset:13312
    ds_read_b128 a[60:63], v8 offset:13312
    ds_read_b128 a[64:67], v7 offset:14336
    ds_read_b128 a[68:71], v8 offset:14336
    ds_read_b128 a[72:75], v7 offset:18432
    ds_read_b128 a[76:79], v8 offset:18432
    ds_read_b128 a[80:83], v7 offset:19456
    ds_read_b128 a[84:87], v8 offset:19456
    ds_read_b128 a[88:91], v7 offset:20480
    ds_read_b128 a[92:95], v8 offset:20480
    ds_read_b128 a[96:99], v7 offset:24576
    ds_read_b128 a[100:103], v8 offset:24576
    ds_read_b128 a[104:107], v7 offset:25600
    ds_read_b128 a[108:111], v8 offset:25600
    ds_read_b128 a[112:115], v7 offset:26624
    ds_read_b128 a[116:119], v8 offset:26624
    ds_read_b128 a[120:123], v7 offset:30720
    ds_read_b128 a[124:127], v8 offset:30720
    ds_read_b128 a[128:131], v7 offset:31744
    ds_read_b128 a[132:135], v8 offset:31744
    ds_read_b128 a[136:139], v7 offset:32768
    ds_read_b128 a[140:143], v8 offset:32768
    ds_read_b128 a[0:3], v7 offset:0
    ds_read_b128 a[4:7], v8 offset:0
    ds_read_b128 a[8:11], v7 offset:1024
    ds_read_b128 a[12:15], v8 offset:1024
    ds_read_b128 a[16:19], v7 offset:2048
    ds_read_b128 a[20:23], v8 offset:2048
    ds_read_b128 a[24:27], v7 offset:6144
    ds_read_b128 a[28:31], v8 offset:6144
    ds_read_b128 a[32:35], v7 offset:7168
    ds_read_b128 a[36:39], v8 offset:7168
    ds_read_b128 a[40:43], v7 offset:8192
    ds_read_b128 a[44:47], v8 offset:8192
    ds_read_b128 a[144:147], v7 offset:36864
    ds_read_b128 a[148:151], v8 offset:36864
    ds_read_b128 a[152:155], v7 offset:37888
    ds_read_b128 a[156:159], v8 offset:37888
    ds_read_b128 a[160:163], v7 offset:38912
    ds_read_b128 a[164:167], v8 offset:38912
    ds_read_b128 a[168:171], v7 offset:43008
    ds_read_b128 a[172:175], v8 offset:43008
    ds_read_b128 a[176:179], v7 offset:44032
    ds_read_b128 a[180:183], v8 offset:44032
    ds_read_b128 a[184:187], v7 offset:45056
    ds_read_b128 a[188:191], v8 offset:45056
    s_waitcnt lgkmcnt(0)
    s_barrier
    s_add_u32 m0, s47, 0
    s_add_i32 s44, s46, 0
    s_max_i32 s44, s44, 0
    s_cmp_eq_u32 s41, 0
    s_cselect_b32 s14, 0, 786432
    buffer_load_dwordx4 v21, s[12:15], s44 offen offset:0 nt lds
    s_add_u32 m0, m0, s51
    s_nop 0
    buffer_load_dwordx4 v21, s[12:15], s44 offen offset:128 nt lds
    s_mov_b32 s14, 786432
    s_add_u32 m0, s47, 98304
    s_add_i32 s44, s46, 98304
    buffer_load_dwordx4 v21, s[12:15], s44 offen offset:0 nt lds
    s_add_u32 m0, m0, s51
    s_nop 0
    buffer_load_dwordx4 v21, s[12:15], s44 offen offset:128 nt lds
    s_add_u32 m0, s47, 12288
    s_add_i32 s44, s46, 12288
    buffer_load_dwordx4 v21, s[12:15], s44 offen offset:0 nt lds
    s_add_u32 m0, m0, s51
    s_nop 0
    buffer_load_dwordx4 v21, s[12:15], s44 offen offset:128 nt lds
    s_add_u32 m0, s47, 110592
    s_add_i32 s44, s46, 110592
    s_min_i32 s44, s44, 783360
    s_cmp_eq_u32 s41, 7
    s_cselect_b32 s14, 0, 786432
    buffer_load_dwordx4 v21, s[12:15], s44 offen offset:0 nt lds
    s_add_u32 m0, m0, s51
    s_nop 0
    buffer_load_dwordx4 v21, s[12:15], s44 offen offset:128 nt lds
    s_mov_b32 s14, 786432
    s_add_u32 m0, s47, 24576
    s_add_i32 s44, s46, 24576
    buffer_load_dwordx4 v21, s[12:15], s44 offen offset:0 nt lds
    s_add_u32 m0, m0, s51
    s_nop 0
    buffer_load_dwordx4 v21, s[12:15], s44 offen offset:128 nt lds
    s_waitcnt lgkmcnt(0)
    v_mfma_f32_16x16x32_bf16 v[168:171], a[48:51], v[144:147], 0
    v_mfma_f32_16x16x32_bf16 v[172:175], a[72:75], v[144:147], 0
    v_mfma_f32_16x16x32_bf16 v[176:179], a[96:99], v[144:147], 0
    v_mfma_f32_16x16x32_bf16 v[180:183], a[120:123], v[144:147], 0
    v_mfma_f32_16x16x32_bf16 v[168:171], a[52:55], v[148:151], v[168:171]
    v_mfma_f32_16x16x32_bf16 v[172:175], a[76:79], v[148:151], v[172:175]
    v_mfma_f32_16x16x32_bf16 v[176:179], a[100:103], v[148:151], v[176:179]
    v_mfma_f32_16x16x32_bf16 v[180:183], a[124:127], v[148:151], v[180:183]
    v_mfma_f32_16x16x32_bf16 v[168:171], a[56:59], v[152:155], v[168:171]
    v_mfma_f32_16x16x32_bf16 v[172:175], a[80:83], v[152:155], v[172:175]
    v_mfma_f32_16x16x32_bf16 v[176:179], a[104:107], v[152:155], v[176:179]
    v_mfma_f32_16x16x32_bf16 v[180:183], a[128:131], v[152:155], v[180:183]
    v_mfma_f32_16x16x32_bf16 v[168:171], a[60:63], v[156:159], v[168:171]
    v_mfma_f32_16x16x32_bf16 v[172:175], a[84:87], v[156:159], v[172:175]
    v_mfma_f32_16x16x32_bf16 v[176:179], a[108:111], v[156:159], v[176:179]
    v_mfma_f32_16x16x32_bf16 v[180:183], a[132:135], v[156:159], v[180:183]
    v_mfma_f32_16x16x32_bf16 v[168:171], a[64:67], v[160:163], v[168:171]
    v_mfma_f32_16x16x32_bf16 v[172:175], a[88:91], v[160:163], v[172:175]
    v_mfma_f32_16x16x32_bf16 v[176:179], a[112:115], v[160:163], v[176:179]
    v_mfma_f32_16x16x32_bf16 v[180:183], a[136:139], v[160:163], v[180:183]
    v_mfma_f32_16x16x32_bf16 v[168:171], a[68:71], v[164:167], v[168:171]
    v_mfma_f32_16x16x32_bf16 v[172:175], a[92:95], v[164:167], v[172:175]
    v_mfma_f32_16x16x32_bf16 v[176:179], a[116:119], v[164:167], v[176:179]
    v_mfma_f32_16x16x32_bf16 v[180:183], a[140:143], v[164:167], v[180:183]
    s_add_u32 m0, s47, 36864
    s_add_i32 s44, s46, 36864
    buffer_load_dwordx4 v21, s[12:15], s44 offen offset:0 nt lds
    s_add_u32 m0, m0, s51
    s_nop 0
    buffer_load_dwordx4 v21, s[12:15], s44 offen offset:128 nt lds
    v_mov_b32 v39, 0
    v_mov_b32 v40, 160256
    s_lshl_b32 s50, s3, 2
    v_add_u32 v47, s50, v30
    v_max3_f32 v36, v168, v169, v170
    v_max3_f32 v36, v36, v171, v172
    v_max3_f32 v36, v36, v173, v174
    v_max3_f32 v36, v36, v175, v176
    v_max3_f32 v36, v36, v177, v178
    v_max3_f32 v36, v36, v179, v180
    v_max3_f32 v36, v36, v181, v182
    v_max_f32 v36, v36, v183
    v_mov_b32 v37, v36
    s_nop 1
    v_permlane32_swap_b32 v36, v37
    v_max_f32 v36, v36, v37
    v_mov_b32 v37, v36
    s_nop 1
    v_permlane16_swap_b32 v36, v37
    v_max_f32 v36, v36, v37
    ds_write_b32 v47, v36
    ds_write_b32 v40, v39
    s_waitcnt vmcnt(18)
    s_add_u32 m0, s47, 49152
    s_add_i32 s44, s46, 49152
    buffer_load_dwordx4 v21, s[12:15], s44 offen offset:0 nt lds
    s_add_u32 m0, m0, s51
    s_nop 0
    buffer_load_dwordx4 v21, s[12:15], s44 offen offset:128 nt lds
    v_mov_b32_dpp v216, v196 row_ror:8 row_mask:0xf bank_mask:0xf
    v_mov_b32_dpp v217, v197 row_ror:8 row_mask:0xf bank_mask:0xf
    v_mov_b32_dpp v218, v198 row_ror:8 row_mask:0xf bank_mask:0xf
    v_mov_b32_dpp v219, v199 row_ror:8 row_mask:0xf bank_mask:0xf
    v_mov_b32_dpp v216, v192 row_ror:8 row_mask:0xf bank_mask:0x3
    v_mov_b32_dpp v217, v193 row_ror:8 row_mask:0xf bank_mask:0x3
    v_mov_b32_dpp v218, v194 row_ror:8 row_mask:0xf bank_mask:0x3
    v_mov_b32_dpp v219, v195 row_ror:8 row_mask:0xf bank_mask:0x3
    v_mov_b32_dpp v192, v196 quad_perm:[0,1,2,3] row_mask:0xf bank_mask:0xc
    v_mov_b32_dpp v193, v197 quad_perm:[0,1,2,3] row_mask:0xf bank_mask:0xc
    v_mov_b32_dpp v194, v198 quad_perm:[0,1,2,3] row_mask:0xf bank_mask:0xc
    v_mov_b32_dpp v195, v199 quad_perm:[0,1,2,3] row_mask:0xf bank_mask:0xc
    s_nop 1
    v_mfma_f32_16x16x32_bf16 v[72:75], a[0:3], v[192:195], v[48:51]
    v_mov_b32_dpp v196, v204 row_ror:8 row_mask:0xf bank_mask:0xf
    v_mfma_f32_16x16x32_bf16 v[76:79], a[24:27], v[192:195], v[52:55]
    v_mov_b32_dpp v197, v205 row_ror:8 row_mask:0xf bank_mask:0xf
    v_mfma_f32_16x16x32_bf16 v[80:83], a[48:51], v[192:195], v[56:59]
    v_mov_b32_dpp v198, v206 row_ror:8 row_mask:0xf bank_mask:0xf
    v_mfma_f32_16x16x32_bf16 v[84:87], a[72:75], v[192:195], v[60:63]
    v_mov_b32_dpp v199, v207 row_ror:8 row_mask:0xf bank_mask:0xf
    v_mfma_f32_16x16x32_bf16 v[88:91], a[96:99], v[192:195], v[64:67]
    v_mov_b32_dpp v196, v200 row_ror:8 row_mask:0xf bank_mask:0x3
    v_mfma_f32_16x16x32_bf16 v[92:95], a[192:195], v[192:195], v[68:71]
    v_mov_b32_dpp v197, v201 row_ror:8 row_mask:0xf bank_mask:0x3
    v_mfma_f32_16x16x32_bf16 v[72:75], a[4:7], v[216:219], v[72:75]
    v_mov_b32_dpp v198, v202 row_ror:8 row_mask:0xf bank_mask:0x3
    v_mfma_f32_16x16x32_bf16 v[76:79], a[28:31], v[216:219], v[76:79]
    v_mov_b32_dpp v199, v203 row_ror:8 row_mask:0xf bank_mask:0x3
    v_mfma_f32_16x16x32_bf16 v[80:83], a[52:55], v[216:219], v[80:83]
    v_mov_b32_dpp v200, v204 quad_perm:[0,1,2,3] row_mask:0xf bank_mask:0xc
    v_mfma_f32_16x16x32_bf16 v[84:87], a[76:79], v[216:219], v[84:87]
    v_mov_b32_dpp v201, v205 quad_perm:[0,1,2,3] row_mask:0xf bank_mask:0xc
    v_mfma_f32_16x16x32_bf16 v[88:91], a[100:103], v[216:219], v[88:91]
    v_mov_b32_dpp v202, v206 quad_perm:[0,1,2,3] row_mask:0xf bank_mask:0xc
    v_mfma_f32_16x16x32_bf16 v[92:95], a[196:199], v[216:219], v[92:95]
    v_mov_b32_dpp v203, v207 quad_perm:[0,1,2,3] row_mask:0xf bank_mask:0xc
    s_nop 1
    v_mfma_f32_16x16x32_bf16 v[72:75], a[8:11], v[200:203], v[72:75]
    v_mov_b32_dpp v204, v212 row_ror:8 row_mask:0xf bank_mask:0xf
    v_mfma_f32_16x16x32_bf16 v[76:79], a[32:35], v[200:203], v[76:79]
    v_mov_b32_dpp v205, v213 row_ror:8 row_mask:0xf bank_mask:0xf
    v_mfma_f32_16x16x32_bf16 v[80:83], a[56:59], v[200:203], v[80:83]
    v_mov_b32_dpp v206, v214 row_ror:8 row_mask:0xf bank_mask:0xf
    v_mfma_f32_16x16x32_bf16 v[84:87], a[80:83], v[200:203], v[84:87]
    v_mov_b32_dpp v207, v215 row_ror:8 row_mask:0xf bank_mask:0xf
    v_mfma_f32_16x16x32_bf16 v[88:91], a[104:107], v[200:203], v[88:91]
    v_mov_b32_dpp v204, v208 row_ror:8 row_mask:0xf bank_mask:0x3
    v_mfma_f32_16x16x32_bf16 v[92:95], a[200:203], v[200:203], v[92:95]
    v_mov_b32_dpp v205, v209 row_ror:8 row_mask:0xf bank_mask:0x3
    v_mfma_f32_16x16x32_bf16 v[72:75], a[12:15], v[196:199], v[72:75]
    v_mov_b32_dpp v206, v210 row_ror:8 row_mask:0xf bank_mask:0x3
    v_mfma_f32_16x16x32_bf16 v[76:79], a[36:39], v[196:199], v[76:79]
    v_mov_b32_dpp v207, v211 row_ror:8 row_mask:0xf bank_mask:0x3
    v_mfma_f32_16x16x32_bf16 v[80:83], a[60:63], v[196:199], v[80:83]
    v_mov_b32_dpp v208, v212 quad_perm:[0,1,2,3] row_mask:0xf bank_mask:0xc
    v_mfma_f32_16x16x32_bf16 v[84:87], a[84:87], v[196:199], v[84:87]
    v_mov_b32_dpp v209, v213 quad_perm:[0,1,2,3] row_mask:0xf bank_mask:0xc
    v_mfma_f32_16x16x32_bf16 v[88:91], a[108:111], v[196:199], v[88:91]
    v_mov_b32_dpp v210, v214 quad_perm:[0,1,2,3] row_mask:0xf bank_mask:0xc
    v_mfma_f32_16x16x32_bf16 v[92:95], a[204:207], v[196:199], v[92:95]
    v_mov_b32_dpp v211, v215 quad_perm:[0,1,2,3] row_mask:0xf bank_mask:0xc
    s_nop 1
    v_mfma_f32_16x16x32_bf16 v[72:75], a[16:19], v[208:211], v[72:75]
    v_mfma_f32_16x16x32_bf16 v[76:79], a[40:43], v[208:211], v[76:79]
    v_mfma_f32_16x16x32_bf16 v[80:83], a[64:67], v[208:211], v[80:83]
    v_mfma_f32_16x16x32_bf16 v[84:87], a[88:91], v[208:211], v[84:87]
    v_mfma_f32_16x16x32_bf16 v[88:91], a[112:115], v[208:211], v[88:91]
    v_mfma_f32_16x16x32_bf16 v[92:95], a[208:211], v[208:211], v[92:95]
    v_mfma_f32_16x16x32_bf16 v[72:75], a[20:23], v[204:207], v[72:75]
    v_mfma_f32_16x16x32_bf16 v[76:79], a[44:47], v[204:207], v[76:79]
    v_mfma_f32_16x16x32_bf16 v[80:83], a[68:71], v[204:207], v[80:83]
    v_mfma_f32_16x16x32_bf16 v[84:87], a[92:95], v[204:207], v[84:87]
    v_mfma_f32_16x16x32_bf16 v[88:91], a[116:119], v[204:207], v[88:91]
    v_mfma_f32_16x16x32_bf16 v[92:95], a[212:215], v[204:207], v[92:95]
    s_add_u32 m0, s47, 61440
    s_add_i32 s44, s46, 61440
    buffer_load_dwordx4 v21, s[12:15], s44 offen offset:0 nt lds
    s_add_u32 m0, m0, s51
    s_nop 0
    buffer_load_dwordx4 v21, s[12:15], s44 offen offset:128 nt lds
    s_cmp_lg_u32 s60, 0
    s_cbranch_scc1 L_noleft1
    v_mov_b32 v52, v3
    v_mov_b32 v53, v3
    v_mov_b32 v54, 0
    v_mov_b32 v55, 0
    v_mov_b32 v56, 0
    v_mov_b32 v57, 0
L_noleft1:
    s_call_b64 s[94:95], F_sm0
    s_waitcnt vmcnt(16)
    s_add_u32 m0, s47, 73728
    s_add_i32 s44, s46, 73728
    buffer_load_dwordx4 v21, s[12:15], s44 offen offset:0 nt lds
    s_add_u32 m0, m0, s51
    s_nop 0
    buffer_load_dwordx4 v21, s[12:15], s44 offen offset:128 nt lds
    v_mov_b32_dpp v244, v224 row_ror:8 row_mask:0xf bank_mask:0xf
    v_mov_b32_dpp v245, v225 row_ror:8 row_mask:0xf bank_mask:0xf
    v_mov_b32_dpp v246, v226 row_ror:8 row_mask:0xf bank_mask:0xf
    v_mov_b32_dpp v247, v227 row_ror:8 row_mask:0xf bank_mask:0xf
    v_mov_b32_dpp v244, v220 row_ror:8 row_mask:0xf bank_mask:0x3
    v_mov_b32_dpp v245, v221 row_ror:8 row_mask:0xf bank_mask:0x3
    v_mov_b32_dpp v246, v222 row_ror:8 row_mask:0xf bank_mask:0x3
    v_mov_b32_dpp v247, v223 row_ror:8 row_mask:0xf bank_mask:0x3
    v_mov_b32_dpp v220, v224 quad_perm:[0,1,2,3] row_mask:0xf bank_mask:0xc
    v_mov_b32_dpp v221, v225 quad_perm:[0,1,2,3] row_mask:0xf bank_mask:0xc
    v_mov_b32_dpp v222, v226 quad_perm:[0,1,2,3] row_mask:0xf bank_mask:0xc
    v_mov_b32_dpp v223, v227 quad_perm:[0,1,2,3] row_mask:0xf bank_mask:0xc
    s_nop 1
    v_mfma_f32_16x16x32_bf16 v[96:99], a[24:27], v[220:223], v[48:51]
    v_mov_b32_dpp v224, v232 row_ror:8 row_mask:0xf bank_mask:0xf
    v_mfma_f32_16x16x32_bf16 v[100:103], a[48:51], v[220:223], v[52:55]
    v_mov_b32_dpp v225, v233 row_ror:8 row_mask:0xf bank_mask:0xf
    v_mfma_f32_16x16x32_bf16 v[104:107], a[72:75], v[220:223], v[56:59]
    v_mov_b32_dpp v226, v234 row_ror:8 row_mask:0xf bank_mask:0xf
    v_mfma_f32_16x16x32_bf16 v[108:111], a[96:99], v[220:223], v[60:63]
    v_mov_b32_dpp v227, v235 row_ror:8 row_mask:0xf bank_mask:0xf
    v_mfma_f32_16x16x32_bf16 v[112:115], a[120:123], v[220:223], v[64:67]
    v_mov_b32_dpp v224, v228 row_ror:8 row_mask:0xf bank_mask:0x3
    v_mfma_f32_16x16x32_bf16 v[116:119], a[192:195], v[220:223], v[68:71]
    v_mov_b32_dpp v225, v229 row_ror:8 row_mask:0xf bank_mask:0x3
    v_mfma_f32_16x16x32_bf16 v[96:99], a[28:31], v[244:247], v[96:99]
    v_mov_b32_dpp v226, v230 row_ror:8 row_mask:0xf bank_mask:0x3
    v_mfma_f32_16x16x32_bf16 v[100:103], a[52:55], v[244:247], v[100:103]
    v_mov_b32_dpp v227, v231 row_ror:8 row_mask:0xf bank_mask:0x3
    v_mfma_f32_16x16x32_bf16 v[104:107], a[76:79], v[244:247], v[104:107]
    v_mov_b32_dpp v228, v232 quad_perm:[0,1,2,3] row_mask:0xf bank_mask:0xc
    v_mfma_f32_16x16x32_bf16 v[108:111], a[100:103], v[244:247], v[108:111]
    v_mov_b32_dpp v229, v233 quad_perm:[0,1,2,3] row_mask:0xf bank_mask:0xc
    v_mfma_f32_16x16x32_bf16 v[112:115], a[124:127], v[244:247], v[112:115]
    v_mov_b32_dpp v230, v234 quad_perm:[0,1,2,3] row_mask:0xf bank_mask:0xc
    v_mfma_f32_16x16x32_bf16 v[116:119], a[196:199], v[244:247], v[116:119]
    v_mov_b32_dpp v231, v235 quad_perm:[0,1,2,3] row_mask:0xf bank_mask:0xc
    s_nop 1
    v_mfma_f32_16x16x32_bf16 v[96:99], a[32:35], v[228:231], v[96:99]
    v_mov_b32_dpp v232, v240 row_ror:8 row_mask:0xf bank_mask:0xf
    v_mfma_f32_16x16x32_bf16 v[100:103], a[56:59], v[228:231], v[100:103]
    v_mov_b32_dpp v233, v241 row_ror:8 row_mask:0xf bank_mask:0xf
    v_mfma_f32_16x16x32_bf16 v[104:107], a[80:83], v[228:231], v[104:107]
    v_mov_b32_dpp v234, v242 row_ror:8 row_mask:0xf bank_mask:0xf
    v_mfma_f32_16x16x32_bf16 v[108:111], a[104:107], v[228:231], v[108:111]
    v_mov_b32_dpp v235, v243 row_ror:8 row_mask:0xf bank_mask:0xf
    v_mfma_f32_16x16x32_bf16 v[112:115], a[128:131], v[228:231], v[112:115]
    v_mov_b32_dpp v232, v236 row_ror:8 row_mask:0xf bank_mask:0x3
    v_mfma_f32_16x16x32_bf16 v[116:119], a[200:203], v[228:231], v[116:119]
    v_mov_b32_dpp v233, v237 row_ror:8 row_mask:0xf bank_mask:0x3
    v_mfma_f32_16x16x32_bf16 v[96:99], a[36:39], v[224:227], v[96:99]
    v_mov_b32_dpp v234, v238 row_ror:8 row_mask:0xf bank_mask:0x3
    v_mfma_f32_16x16x32_bf16 v[100:103], a[60:63], v[224:227], v[100:103]
    v_mov_b32_dpp v235, v239 row_ror:8 row_mask:0xf bank_mask:0x3
    v_mfma_f32_16x16x32_bf16 v[104:107], a[84:87], v[224:227], v[104:107]
    v_mov_b32_dpp v236, v240 quad_perm:[0,1,2,3] row_mask:0xf bank_mask:0xc
    v_mfma_f32_16x16x32_bf16 v[108:111], a[108:111], v[224:227], v[108:111]
    v_mov_b32_dpp v237, v241 quad_perm:[0,1,2,3] row_mask:0xf bank_mask:0xc
    v_mfma_f32_16x16x32_bf16 v[112:115], a[132:135], v[224:227], v[112:115]
    v_mov_b32_dpp v238, v242 quad_perm:[0,1,2,3] row_mask:0xf bank_mask:0xc
    v_mfma_f32_16x16x32_bf16 v[116:119], a[204:207], v[224:227], v[116:119]
    v_mov_b32_dpp v239, v243 quad_perm:[0,1,2,3] row_mask:0xf bank_mask:0xc
    s_nop 1
    v_mfma_f32_16x16x32_bf16 v[96:99], a[40:43], v[236:239], v[96:99]
    v_mfma_f32_16x16x32_bf16 v[100:103], a[64:67], v[236:239], v[100:103]
    v_mfma_f32_16x16x32_bf16 v[104:107], a[88:91], v[236:239], v[104:107]
    v_mfma_f32_16x16x32_bf16 v[108:111], a[112:115], v[236:239], v[108:111]
    v_mfma_f32_16x16x32_bf16 v[112:115], a[136:139], v[236:239], v[112:115]
    v_mfma_f32_16x16x32_bf16 v[116:119], a[208:211], v[236:239], v[116:119]
    v_mfma_f32_16x16x32_bf16 v[96:99], a[44:47], v[232:235], v[96:99]
    v_mfma_f32_16x16x32_bf16 v[100:103], a[68:71], v[232:235], v[100:103]
    v_mfma_f32_16x16x32_bf16 v[104:107], a[92:95], v[232:235], v[104:107]
    v_mfma_f32_16x16x32_bf16 v[108:111], a[116:119], v[232:235], v[108:111]
    v_mfma_f32_16x16x32_bf16 v[112:115], a[140:143], v[232:235], v[112:115]
    v_mfma_f32_16x16x32_bf16 v[116:119], a[212:215], v[232:235], v[116:119]
    s_add_u32 m0, s47, 86016
    s_add_i32 s44, s46, 86016
    buffer_load_dwordx4 v21, s[12:15], s44 offen offset:0 nt lds
    s_add_u32 m0, m0, s51
    s_nop 0
    buffer_load_dwordx4 v21, s[12:15], s44 offen offset:128 nt lds
    s_call_b64 s[94:95], F_sm1
    s_add_u32 m0, s47, 1792
    s_add_i32 s44, s46, 0
    s_max_i32 s44, s44, 0
    s_cmp_eq_u32 s41, 0
    s_cselect_b32 s14, 0, 786432
    buffer_load_dwordx4 v21, s[12:15], s44 offen offset:256 nt lds
    s_mov_b32 s14, 786432
    s_add_u32 m0, s47, 100096
    s_add_i32 s44, s46, 98304
    buffer_load_dwordx4 v21, s[12:15], s44 offen offset:256 nt lds
    s_waitcnt lgkmcnt(0)
    s_barrier
    ds_read_b128 v[40:43], v30
    s_add_u32 m0, s47, 14080
    s_add_i32 s44, s46, 12288
    buffer_load_dwordx4 v21, s[12:15], s44 offen offset:256 nt lds
    s_add_u32 m0, s47, 112384
    s_add_i32 s44, s46, 110592
    s_min_i32 s44, s44, 783360
    s_cmp_eq_u32 s41, 7
    s_cselect_b32 s14, 0, 786432
    buffer_load_dwordx4 v21, s[12:15], s44 offen offset:256 nt lds
    s_mov_b32 s14, 786432
    s_waitcnt lgkmcnt(0)
    v_max3_f32 v36, v40, v41, v42
    v_max_f32 v36, v36, v43
    v_mul_f32 v44, s49, v36
    v_fma_f32 v168, v168, s49, -v44
    v_fma_f32 v169, v169, s49, -v44
    v_fma_f32 v170, v170, s49, -v44
    v_fma_f32 v171, v171, s49, -v44
    v_fma_f32 v172, v172, s49, -v44
    v_fma_f32 v173, v173, s49, -v44
    v_fma_f32 v174, v174, s49, -v44
    v_fma_f32 v175, v175, s49, -v44
    v_fma_f32 v176, v176, s49, -v44
    v_fma_f32 v177, v177, s49, -v44
    v_fma_f32 v178, v178, s49, -v44
    v_fma_f32 v179, v179, s49, -v44
    v_fma_f32 v180, v180, s49, -v44
    v_fma_f32 v181, v181, s49, -v44
    v_fma_f32 v182, v182, s49, -v44
    v_fma_f32 v183, v183, s49, -v44
    v_exp_f32 v168, v168
    v_exp_f32 v169, v169
    v_exp_f32 v170, v170
    v_exp_f32 v171, v171
    v_exp_f32 v172, v172
    v_exp_f32 v173, v173
    v_exp_f32 v174, v174
    v_exp_f32 v175, v175
    v_exp_f32 v176, v176
    v_exp_f32 v177, v177
    v_exp_f32 v178, v178
    v_exp_f32 v179, v179
    v_exp_f32 v180, v180
    v_exp_f32 v181, v181
    v_exp_f32 v182, v182
    v_exp_f32 v183, v183
    v_add_f32 v38, v168, v169
    v_add_f32 v38, v38, v170
    v_add_f32 v38, v38, v171
    v_add_f32 v38, v38, v172
    v_add_f32 v38, v38, v173
    v_add_f32 v38, v38, v174
    v_add_f32 v38, v38, v175
    v_add_f32 v38, v38, v176
    v_add_f32 v38, v38, v177
    v_add_f32 v38, v38, v178
    v_add_f32 v38, v38, v179
    v_add_f32 v38, v38, v180
    v_add_f32 v38, v38, v181
    v_add_f32 v38, v38, v182
    v_add_f32 v38, v38, v183
    v_cvt_pk_bf16_f32 v144, v168, v169
    v_cvt_pk_bf16_f32 v145, v170, v171
    v_cvt_pk_bf16_f32 v146, v172, v173
    v_cvt_pk_bf16_f32 v147, v174, v175
    v_cvt_pk_bf16_f32 v148, v176, v177
    v_cvt_pk_bf16_f32 v149, v178, v179
    v_cvt_pk_bf16_f32 v150, v180, v181
    v_cvt_pk_bf16_f32 v151, v182, v183
    v_mov_b32 v37, v38
    s_nop 1
    v_permlane32_swap_b32 v38, v37
    v_add_f32 v38, v38, v37
    v_mov_b32 v37, v38
    s_nop 1
    v_permlane16_swap_b32 v38, v37
    v_add_f32 v38, v38, v37
    ds_write_b128 v28, v[144:147] offset:6144
    ds_write_b128 v28, v[148:151] offset:7168
    ds_write_b32 v47, v38 offset:256
    s_add_u32 m0, s47, 26368
    s_add_i32 s44, s46, 24576
    buffer_load_dwordx4 v21, s[12:15], s44 offen offset:256 nt lds
    s_add_u32 m0, s47, 38656
    s_add_i32 s44, s46, 36864
    buffer_load_dwordx4 v21, s[12:15], s44 offen offset:256 nt lds
    s_add_u32 m0, s47, 50944
    s_add_i32 s44, s46, 49152
    buffer_load_dwordx4 v21, s[12:15], s44 offen offset:256 nt lds
    s_add_u32 m0, s47, 63232
    s_add_i32 s44, s46, 61440
    buffer_load_dwordx4 v21, s[12:15], s44 offen offset:256 nt lds
    s_add_u32 m0, s47, 75520
    s_add_i32 s44, s46, 73728
    buffer_load_dwordx4 v21, s[12:15], s44 offen offset:256 nt lds
    s_add_u32 m0, s47, 87808
    s_add_i32 s44, s46, 86016
    buffer_load_dwordx4 v21, s[12:15], s44 offen offset:256 nt lds
    s_cmp_lg_u32 s60, 0
    s_cbranch_scc1 L_noleft2
    v_mov_b32 v50, v6
    v_mov_b32 v51, v190
    v_mov_b32 v52, 0
    v_mov_b32 v53, 0
    v_min_f32 v48, v4, v3
    v_min_f32 v49, v5, v3
L_noleft2:
    s_cmp_lg_u32 s60, 1984
    s_cbranch_scc1 L_noright2
    v_mov_b32 v64, v35
    v_mov_b32 v65, v35
    v_mov_b32 v66, v35
    v_mov_b32 v67, v35
L_noright2:
    s_mov_b32 s56, 0
    s_mov_b32 s61, 0
    s_waitcnt vmcnt(10) lgkmcnt(0)
    s_barrier
    ds_read_b128 v[72:75], v29 offset:0
    ds_read_b64_tr_b16 v[176:177], v25 offset:0
    ds_read_b64_tr_b16 v[178:179], v25 offset:6144
    ds_read_b64_tr_b16 v[180:181], v25 offset:1024
    ds_read_b64_tr_b16 v[182:183], v25 offset:7168
    ds_read_b128 v[76:79], v29 offset:1024
    ds_read_b128 v[80:83], v29 offset:9216
    ds_read_b128 v[84:87], v29 offset:10240
    ds_read_b128 v[88:91], v29 offset:18432
    ds_read_b128 v[92:95], v29 offset:19456
    ds_read_b128 v[96:99], v29 offset:27648
    ds_read_b128 v[100:103], v29 offset:28672
    ds_read_b128 v[40:43], v30 offset:256
    ds_read_b64_tr_b16 a[216:217], v25 offset:12288
    ds_read_b64_tr_b16 a[218:219], v25 offset:18432
    ds_read_b64_tr_b16 a[220:221], v25 offset:13312
    ds_read_b64_tr_b16 a[222:223], v25 offset:19456
    ds_read_b64_tr_b16 a[230:231], v25 offset:24576
    ds_read_b64_tr_b16 a[232:233], v25 offset:30720
    ds_read_b64_tr_b16 a[234:235], v25 offset:25600
    ds_read_b64_tr_b16 a[236:237], v25 offset:31744
    ds_read_b64_tr_b16 a[0:1], v25 offset:36864
    ds_read_b64_tr_b16 a[2:3], v25 offset:43008
    ds_read_b64_tr_b16 a[4:5], v25 offset:37888
    ds_read_b64_tr_b16 a[6:7], v25 offset:44032
    s_waitcnt lgkmcnt(15)
    v_mfma_f32_16x16x32_bf16 v[104:107], v[176:179], v[72:75], 0
    v_mfma_f32_16x16x32_bf16 v[108:111], v[180:183], v[72:75], 0
    s_waitcnt lgkmcnt(8)
    v_mfma_f32_16x16x32_bf16 v[104:107], a[216:219], v[76:79], v[104:107]
    ds_read_b64_tr_b16 v[176:177], v26 offset:0
    ds_read_b64_tr_b16 v[178:179], v26 offset:6144
    v_mfma_f32_16x16x32_bf16 v[108:111], a[220:223], v[76:79], v[108:111]
    ds_read_b64_tr_b16 v[180:181], v26 offset:1024
    ds_read_b64_tr_b16 v[182:183], v26 offset:7168
    s_waitcnt lgkmcnt(8)
    v_mfma_f32_16x16x32_bf16 v[104:107], a[230:233], v[80:83], v[104:107]
    ds_read_b64_tr_b16 a[216:217], v26 offset:12288
    ds_read_b64_tr_b16 a[218:219], v26 offset:18432
    v_mfma_f32_16x16x32_bf16 v[108:111], a[234:237], v[80:83], v[108:111]
    ds_read_b64_tr_b16 a[220:221], v26 offset:13312
    ds_read_b64_tr_b16 a[222:223], v26 offset:19456
    s_waitcnt lgkmcnt(8)
    v_mfma_f32_16x16x32_bf16 v[104:107], a[0:3], v[84:87], v[104:107]
    ds_read_b64_tr_b16 a[230:231], v26 offset:24576
    ds_read_b64_tr_b16 a[232:233], v26 offset:30720
    v_mfma_f32_16x16x32_bf16 v[108:111], a[4:7], v[84:87], v[108:111]
    ds_read_b64_tr_b16 a[234:235], v26 offset:25600
    ds_read_b64_tr_b16 a[236:237], v26 offset:31744
    s_waitcnt lgkmcnt(8)
    v_mfma_f32_16x16x32_bf16 v[104:107], v[176:179], v[88:91], v[104:107]
    ds_read_b64_tr_b16 a[0:1], v26 offset:36864
    ds_read_b64_tr_b16 a[2:3], v26 offset:43008
    v_add_f32 v45, v40, v41
    v_add_f32 v45, v45, v42
    v_mfma_f32_16x16x32_bf16 v[108:111], v[180:183], v[88:91], v[108:111]
    ds_read_b64_tr_b16 a[4:5], v26 offset:37888
    ds_read_b64_tr_b16 a[6:7], v26 offset:44032
    v_add_f32 v45, v45, v43
    s_waitcnt lgkmcnt(8)
    v_mfma_f32_16x16x32_bf16 v[104:107], a[216:219], v[92:95], v[104:107]
    ds_read_b64_tr_b16 v[176:177], v16 offset:0
    ds_read_b64_tr_b16 v[178:179], v20 offset:8192
    ds_read_b64_tr_b16 v[182:183], v16 offset:6144
    ds_read_b64_tr_b16 v[184:185], v16 offset:12288
    v_mfma_f32_16x16x32_bf16 v[108:111], a[220:223], v[92:95], v[108:111]
    ds_read_b64_tr_b16 v[186:187], v16 offset:18432
    ds_read_b64_tr_b16 v[188:189], v16 offset:24576
    ds_read_b64_tr_b16 v[180:181], v16 offset:30720
    s_waitcnt lgkmcnt(11)
    v_mfma_f32_16x16x32_bf16 v[104:107], a[230:233], v[96:99], v[104:107]
    ds_read_b64_tr_b16 a[216:217], v17 offset:0
    ds_read_b64_tr_b16 a[218:219], v20 offset:8224
    ds_read_b64_tr_b16 a[222:223], v17 offset:6144
    ds_read_b64_tr_b16 a[224:225], v17 offset:12288
    v_mfma_f32_16x16x32_bf16 v[108:111], a[234:237], v[96:99], v[108:111]
    ds_read_b64_tr_b16 a[226:227], v17 offset:18432
    ds_read_b64_tr_b16 a[228:229], v17 offset:24576
    ds_read_b64_tr_b16 a[220:221], v17 offset:30720
    s_waitcnt lgkmcnt(14)
    v_mfma_f32_16x16x32_bf16 v[104:107], a[0:3], v[100:103], v[104:107]
    ds_read_b64_tr_b16 a[230:231], v18 offset:0
    ds_read_b64_tr_b16 a[232:233], v20 offset:8256
    ds_read_b64_tr_b16 a[236:237], v18 offset:6144
    ds_read_b64_tr_b16 a[238:239], v18 offset:12288
    v_mfma_f32_16x16x32_bf16 v[108:111], a[4:7], v[100:103], v[108:111]
    ds_read_b64_tr_b16 a[240:241], v18 offset:18432
    ds_read_b64_tr_b16 a[242:243], v18 offset:24576
    ds_read_b64_tr_b16 a[234:235], v18 offset:30720
    s_call_b64 s[94:95], F_pv
    ds_read_b64_tr_b16 v[176:177], v25 offset:2048
    ds_read_b64_tr_b16 v[178:179], v25 offset:8192
    ds_read_b64_tr_b16 v[180:181], v25 offset:14336
    ds_read_b64_tr_b16 v[182:183], v25 offset:20480
    ds_read_b64_tr_b16 v[184:185], v25 offset:26624
    ds_read_b64_tr_b16 v[186:187], v25 offset:32768
    ds_read_b64_tr_b16 a[216:217], v25 offset:38912
    ds_read_b64_tr_b16 a[218:219], v25 offset:45056
    ds_read_b64_tr_b16 a[220:221], v26 offset:2048
    ds_read_b64_tr_b16 a[222:223], v26 offset:8192
    ds_read_b64_tr_b16 a[224:225], v26 offset:14336
    ds_read_b64_tr_b16 a[226:227], v26 offset:20480
    ds_read_b64_tr_b16 a[230:231], v26 offset:26624
    ds_read_b64_tr_b16 a[232:233], v26 offset:32768
    ds_read_b64_tr_b16 a[234:235], v26 offset:38912
    ds_read_b64_tr_b16 a[236:237], v26 offset:45056
    s_waitcnt lgkmcnt(10)
    v_mfma_f32_16x16x32_bf16 v[112:115], v[176:179], v[72:75], 0
    v_mfma_f32_16x16x32_bf16 v[112:115], v[180:183], v[76:79], v[112:115]
    v_mfma_f32_16x16x32_bf16 v[112:115], v[184:187], v[80:83], v[112:115]
    s_waitcnt lgkmcnt(4)
    v_mfma_f32_16x16x32_bf16 v[112:115], a[216:219], v[84:87], v[112:115]
    v_mfma_f32_16x16x32_bf16 v[112:115], a[220:223], v[88:91], v[112:115]
    v_mfma_f32_16x16x32_bf16 v[112:115], a[224:227], v[92:95], v[112:115]
    s_waitcnt lgkmcnt(0)
    v_mfma_f32_16x16x32_bf16 v[112:115], a[230:233], v[96:99], v[112:115]
    v_mfma_f32_16x16x32_bf16 v[112:115], a[234:237], v[100:103], v[112:115]
    s_mov_b32 s57, s42
    s_waitcnt vmcnt(6)
    v_mov_b32_dpp v216, v196 row_ror:8 row_mask:0xf bank_mask:0xf
    v_mov_b32_dpp v217, v197 row_ror:8 row_mask:0xf bank_mask:0xf
    v_mov_b32_dpp v218, v198 row_ror:8 row_mask:0xf bank_mask:0xf
    v_mov_b32_dpp v219, v199 row_ror:8 row_mask:0xf bank_mask:0xf
    v_mov_b32_dpp v216, v192 row_ror:8 row_mask:0xf bank_mask:0x3
    v_mov_b32_dpp v217, v193 row_ror:8 row_mask:0xf bank_mask:0x3
    v_mov_b32_dpp v218, v194 row_ror:8 row_mask:0xf bank_mask:0x3
    v_mov_b32_dpp v219, v195 row_ror:8 row_mask:0xf bank_mask:0x3
    v_mov_b32_dpp v192, v196 quad_perm:[0,1,2,3] row_mask:0xf bank_mask:0xc
    v_mov_b32_dpp v193, v197 quad_perm:[0,1,2,3] row_mask:0xf bank_mask:0xc
    v_mov_b32_dpp v194, v198 quad_perm:[0,1,2,3] row_mask:0xf bank_mask:0xc
    v_mov_b32_dpp v195, v199 quad_perm:[0,1,2,3] row_mask:0xf bank_mask:0xc
    s_nop 1
    v_mfma_f32_16x16x32_bf16 v[72:75], a[48:51], v[192:195], v[48:51]
    buffer_store_dwordx2 v[44:45], v32, s[20:23], 0 offen sc1
    v_mov_b32_dpp v196, v204 row_ror:8 row_mask:0xf bank_mask:0xf
    v_mfma_f32_16x16x32_bf16 v[76:79], a[72:75], v[192:195], v[52:55]
    v_mov_b32_dpp v197, v205 row_ror:8 row_mask:0xf bank_mask:0xf
    v_mfma_f32_16x16x32_bf16 v[80:83], a[96:99], v[192:195], v[56:59]
    v_mov_b32_dpp v198, v206 row_ror:8 row_mask:0xf bank_mask:0xf
    v_mfma_f32_16x16x32_bf16 v[84:87], a[120:123], v[192:195], v[60:63]
    v_mov_b32_dpp v199, v207 row_ror:8 row_mask:0xf bank_mask:0xf
    v_mfma_f32_16x16x32_bf16 v[88:91], a[144:147], v[192:195], v[64:67]
    v_mov_b32_dpp v196, v200 row_ror:8 row_mask:0xf bank_mask:0x3
    v_mfma_f32_16x16x32_bf16 v[92:95], a[192:195], v[192:195], v[68:71]
    v_mov_b32_dpp v197, v201 row_ror:8 row_mask:0xf bank_mask:0x3
    v_mfma_f32_16x16x32_bf16 v[72:75], a[52:55], v[216:219], v[72:75]
    v_mov_b32_dpp v198, v202 row_ror:8 row_mask:0xf bank_mask:0x3
    v_mfma_f32_16x16x32_bf16 v[76:79], a[76:79], v[216:219], v[76:79]
    v_mov_b32_dpp v199, v203 row_ror:8 row_mask:0xf bank_mask:0x3
    v_mfma_f32_16x16x32_bf16 v[80:83], a[100:103], v[216:219], v[80:83]
    v_mov_b32_dpp v200, v204 quad_perm:[0,1,2,3] row_mask:0xf bank_mask:0xc
    v_mfma_f32_16x16x32_bf16 v[84:87], a[124:127], v[216:219], v[84:87]
    v_mov_b32_dpp v201, v205 quad_perm:[0,1,2,3] row_mask:0xf bank_mask:0xc
    v_mfma_f32_16x16x32_bf16 v[88:91], a[148:151], v[216:219], v[88:91]
    v_mov_b32_dpp v202, v206 quad_perm:[0,1,2,3] row_mask:0xf bank_mask:0xc
    v_mfma_f32_16x16x32_bf16 v[92:95], a[196:199], v[216:219], v[92:95]
    v_mov_b32_dpp v203, v207 quad_perm:[0,1,2,3] row_mask:0xf bank_mask:0xc
    s_nop 1
    v_mfma_f32_16x16x32_bf16 v[72:75], a[56:59], v[200:203], v[72:75]
    buffer_store_dwordx4 v[104:107], v31, s[20:23], 0 offen offset:0 sc1
    v_mov_b32_dpp v204, v212 row_ror:8 row_mask:0xf bank_mask:0xf
    v_mfma_f32_16x16x32_bf16 v[76:79], a[80:83], v[200:203], v[76:79]
    v_mov_b32_dpp v205, v213 row_ror:8 row_mask:0xf bank_mask:0xf
    v_mfma_f32_16x16x32_bf16 v[80:83], a[104:107], v[200:203], v[80:83]
    v_mov_b32_dpp v206, v214 row_ror:8 row_mask:0xf bank_mask:0xf
    v_mfma_f32_16x16x32_bf16 v[84:87], a[128:131], v[200:203], v[84:87]
    v_mov_b32_dpp v207, v215 row_ror:8 row_mask:0xf bank_mask:0xf
    v_mfma_f32_16x16x32_bf16 v[88:91], a[152:155], v[200:203], v[88:91]
    v_mov_b32_dpp v204, v208 row_ror:8 row_mask:0xf bank_mask:0x3
    v_mfma_f32_16x16x32_bf16 v[92:95], a[200:203], v[200:203], v[92:95]
    v_mov_b32_dpp v205, v209 row_ror:8 row_mask:0xf bank_mask:0x3
    v_mfma_f32_16x16x32_bf16 v[72:75], a[60:63], v[196:199], v[72:75]
    v_mov_b32_dpp v206, v210 row_ror:8 row_mask:0xf bank_mask:0x3
    v_mfma_f32_16x16x32_bf16 v[76:79], a[84:87], v[196:199], v[76:79]
    v_mov_b32_dpp v207, v211 row_ror:8 row_mask:0xf bank_mask:0x3
    v_mfma_f32_16x16x32_bf16 v[80:83], a[108:111], v[196:199], v[80:83]
    v_mov_b32_dpp v208, v212 quad_perm:[0,1,2,3] row_mask:0xf bank_mask:0xc
    v_mfma_f32_16x16x32_bf16 v[84:87], a[132:135], v[196:199], v[84:87]
    v_mov_b32_dpp v209, v213 quad_perm:[0,1,2,3] row_mask:0xf bank_mask:0xc
    v_mfma_f32_16x16x32_bf16 v[88:91], a[156:159], v[196:199], v[88:91]
    v_mov_b32_dpp v210, v214 quad_perm:[0,1,2,3] row_mask:0xf bank_mask:0xc
    v_mfma_f32_16x16x32_bf16 v[92:95], a[204:207], v[196:199], v[92:95]
    v_mov_b32_dpp v211, v215 quad_perm:[0,1,2,3] row_mask:0xf bank_mask:0xc
    s_nop 1
    v_mfma_f32_16x16x32_bf16 v[72:75], a[64:67], v[208:211], v[72:75]
    buffer_store_dwordx4 v[108:111], v31, s[20:23], 0 offen offset:256 sc1
    v_mfma_f32_16x16x32_bf16 v[76:79], a[88:91], v[208:211], v[76:79]
    v_mfma_f32_16x16x32_bf16 v[80:83], a[112:115], v[208:211], v[80:83]
    v_mfma_f32_16x16x32_bf16 v[84:87], a[136:139], v[208:211], v[84:87]
    v_mfma_f32_16x16x32_bf16 v[88:91], a[160:163], v[208:211], v[88:91]
    v_mfma_f32_16x16x32_bf16 v[92:95], a[208:211], v[208:211], v[92:95]
    v_mfma_f32_16x16x32_bf16 v[72:75], a[68:71], v[204:207], v[72:75]
    buffer_store_dwordx4 v[112:115], v31, s[20:23], 0 offen offset:512 sc1
    v_mfma_f32_16x16x32_bf16 v[76:79], a[92:95], v[204:207], v[76:79]
    v_mfma_f32_16x16x32_bf16 v[80:83], a[116:119], v[204:207], v[80:83]
    v_mfma_f32_16x16x32_bf16 v[84:87], a[140:143], v[204:207], v[84:87]
    v_mfma_f32_16x16x32_bf16 v[88:91], a[164:167], v[204:207], v[88:91]
    v_mfma_f32_16x16x32_bf16 v[92:95], a[212:215], v[204:207], v[92:95]
    s_cmp_lg_u32 s60, 0
    s_cbranch_scc1 L_noleft3
    v_mov_b32 v48, v4
    v_mov_b32 v49, v5
L_noleft3:
    s_cmp_lg_u32 s60, 1984
    s_cbranch_scc1 L_noright3
    v_mov_b32 v60, v35
    v_mov_b32 v61, v35
    v_mov_b32 v62, v35
    v_mov_b32 v63, v35
L_noright3:
    s_call_b64 s[94:95], F_sm0
    s_waitcnt vmcnt(0)
    v_mov_b32 v41, 1
    v_mov_b32 v40, 160256
    s_mov_b64 exec, 1
    ds_add_rtn_u32 v29, v40, v41
    s_mov_b64 exec, -1
    v_add_u32 v16, 12288, v16
    v_add_u32 v17, 12288, v17
    v_add_u32 v18, 12288, v18
    v_add_u32 v19, 12288, v19
    s_waitcnt lgkmcnt(0)
    v_readfirstlane_b32 s61, v29
    s_nop 0
    s_cmp_lg_u32 s61, 3
    s_cbranch_scc1 L_nosig
    s_lshl_b32 s44, s40, 2
    v_mov_b32 v40, s44
    v_mov_b32 v28, 1
    s_mov_b64 exec, 1
    buffer_atomic_add v28, v40, s[24:27], 0 offen sc0
    s_mov_b64 exec, -1
L_nosig:
    v_mov_b32_dpp v244, v224 row_ror:8 row_mask:0xf bank_mask:0xf
    v_mov_b32_dpp v245, v225 row_ror:8 row_mask:0xf bank_mask:0xf
    v_mov_b32_dpp v246, v226 row_ror:8 row_mask:0xf bank_mask:0xf
    v_mov_b32_dpp v247, v227 row_ror:8 row_mask:0xf bank_mask:0xf
    v_mov_b32_dpp v244, v220 row_ror:8 row_mask:0xf bank_mask:0x3
    v_mov_b32_dpp v245, v221 row_ror:8 row_mask:0xf bank_mask:0x3
    v_mov_b32_dpp v246, v222 row_ror:8 row_mask:0xf bank_mask:0x3
    v_mov_b32_dpp v247, v223 row_ror:8 row_mask:0xf bank_mask:0x3
    v_mov_b32_dpp v220, v224 quad_perm:[0,1,2,3] row_mask:0xf bank_mask:0xc
    v_mov_b32_dpp v221, v225 quad_perm:[0,1,2,3] row_mask:0xf bank_mask:0xc
    v_mov_b32_dpp v222, v226 quad_perm:[0,1,2,3] row_mask:0xf bank_mask:0xc
    v_mov_b32_dpp v223, v227 quad_perm:[0,1,2,3] row_mask:0xf bank_mask:0xc
    s_nop 1
    v_mfma_f32_16x16x32_bf16 v[96:99], a[72:75], v[220:223], v[48:51]
    ds_read_b64_tr_b16 v[176:177], v16 offset:0
    v_mov_b32_dpp v224, v232 row_ror:8 row_mask:0xf bank_mask:0xf
    v_mfma_f32_16x16x32_bf16 v[100:103], a[96:99], v[220:223], v[52:55]
    ds_read_b64_tr_b16 v[178:179], v20 offset:8192
    v_mov_b32_dpp v225, v233 row_ror:8 row_mask:0xf bank_mask:0xf
    v_mfma_f32_16x16x32_bf16 v[104:107], a[120:123], v[220:223], v[56:59]
    v_mov_b32_dpp v226, v234 row_ror:8 row_mask:0xf bank_mask:0xf
    v_mfma_f32_16x16x32_bf16 v[108:111], a[144:147], v[220:223], v[60:63]
    ds_read_b64_tr_b16 v[182:183], v16 offset:6144
    v_mov_b32_dpp v227, v235 row_ror:8 row_mask:0xf bank_mask:0xf
    v_mfma_f32_16x16x32_bf16 v[112:115], a[168:171], v[220:223], v[64:67]
    v_mov_b32_dpp v224, v228 row_ror:8 row_mask:0xf bank_mask:0x3
    v_mfma_f32_16x16x32_bf16 v[116:119], a[192:195], v[220:223], v[68:71]
    ds_read_b64_tr_b16 v[184:185], v16 offset:12288
    v_mov_b32_dpp v225, v229 row_ror:8 row_mask:0xf bank_mask:0x3
    v_mfma_f32_16x16x32_bf16 v[96:99], a[76:79], v[244:247], v[96:99]
    ds_read_b64_tr_b16 v[186:187], v16 offset:18432
    v_mov_b32_dpp v226, v230 row_ror:8 row_mask:0xf bank_mask:0x3
    v_mfma_f32_16x16x32_bf16 v[100:103], a[100:103], v[244:247], v[100:103]
    v_mov_b32_dpp v227, v231 row_ror:8 row_mask:0xf bank_mask:0x3
    v_mfma_f32_16x16x32_bf16 v[104:107], a[124:127], v[244:247], v[104:107]
    ds_read_b64_tr_b16 v[188:189], v16 offset:24576
    v_mov_b32_dpp v228, v232 quad_perm:[0,1,2,3] row_mask:0xf bank_mask:0xc
    v_mfma_f32_16x16x32_bf16 v[108:111], a[148:151], v[244:247], v[108:111]
    v_mov_b32_dpp v229, v233 quad_perm:[0,1,2,3] row_mask:0xf bank_mask:0xc
    v_mfma_f32_16x16x32_bf16 v[112:115], a[172:175], v[244:247], v[112:115]
    ds_read_b64_tr_b16 v[180:181], v16 offset:30720
    v_mov_b32_dpp v230, v234 quad_perm:[0,1,2,3] row_mask:0xf bank_mask:0xc
    v_mfma_f32_16x16x32_bf16 v[116:119], a[196:199], v[244:247], v[116:119]
    v_mov_b32_dpp v231, v235 quad_perm:[0,1,2,3] row_mask:0xf bank_mask:0xc
    s_nop 1
    v_mfma_f32_16x16x32_bf16 v[96:99], a[80:83], v[228:231], v[96:99]
    ds_read_b64_tr_b16 a[216:217], v17 offset:0
    v_mov_b32_dpp v232, v240 row_ror:8 row_mask:0xf bank_mask:0xf
    v_mfma_f32_16x16x32_bf16 v[100:103], a[104:107], v[228:231], v[100:103]
    ds_read_b64_tr_b16 a[218:219], v20 offset:8224
    v_mov_b32_dpp v233, v241 row_ror:8 row_mask:0xf bank_mask:0xf
    v_mfma_f32_16x16x32_bf16 v[104:107], a[128:131], v[228:231], v[104:107]
    v_mov_b32_dpp v234, v242 row_ror:8 row_mask:0xf bank_mask:0xf
    v_mfma_f32_16x16x32_bf16 v[108:111], a[152:155], v[228:231], v[108:111]
    ds_read_b64_tr_b16 a[222:223], v17 offset:6144
    v_mov_b32_dpp v235, v243 row_ror:8 row_mask:0xf bank_mask:0xf
    v_mfma_f32_16x16x32_bf16 v[112:115], a[176:179], v[228:231], v[112:115]
    v_mov_b32_dpp v232, v236 row_ror:8 row_mask:0xf bank_mask:0x3
    v_mfma_f32_16x16x32_bf16 v[116:119], a[200:203], v[228:231], v[116:119]
    ds_read_b64_tr_b16 a[224:225], v17 offset:12288
    v_mov_b32_dpp v233, v237 row_ror:8 row_mask:0xf bank_mask:0x3
    v_mfma_f32_16x16x32_bf16 v[96:99], a[84:87], v[224:227], v[96:99]
    ds_read_b64_tr_b16 a[226:227], v17 offset:18432
    v_mov_b32_dpp v234, v238 row_ror:8 row_mask:0xf bank_mask:0x3
    v_mfma_f32_16x16x32_bf16 v[100:103], a[108:111], v[224:227], v[100:103]
    v_mov_b32_dpp v235, v239 row_ror:8 row_mask:0xf bank_mask:0x3
    v_mfma_f32_16x16x32_bf16 v[104:107], a[132:135], v[224:227], v[104:107]
    ds_read_b64_tr_b16 a[228:229], v17 offset:24576
    v_mov_b32_dpp v236, v240 quad_perm:[0,1,2,3] row_mask:0xf bank_mask:0xc
    v_mfma_f32_16x16x32_bf16 v[108:111], a[156:159], v[224:227], v[108:111]
    v_mov_b32_dpp v237, v241 quad_perm:[0,1,2,3] row_mask:0xf bank_mask:0xc
    v_mfma_f32_16x16x32_bf16 v[112:115], a[180:183], v[224:227], v[112:115]
    ds_read_b64_tr_b16 a[220:221], v17 offset:30720
    v_mov_b32_dpp v238, v242 quad_perm:[0,1,2,3] row_mask:0xf bank_mask:0xc
    v_mfma_f32_16x16x32_bf16 v[116:119], a[204:207], v[224:227], v[116:119]
    v_mov_b32_dpp v239, v243 quad_perm:[0,1,2,3] row_mask:0xf bank_mask:0xc
    s_nop 1
    v_mfma_f32_16x16x32_bf16 v[96:99], a[88:91], v[236:239], v[96:99]
    ds_read_b64_tr_b16 a[230:231], v18 offset:0
    v_mfma_f32_16x16x32_bf16 v[100:103], a[112:115], v[236:239], v[100:103]
    ds_read_b64_tr_b16 a[232:233], v20 offset:8256
    v_mfma_f32_16x16x32_bf16 v[104:107], a[136:139], v[236:239], v[104:107]
    v_mfma_f32_16x16x32_bf16 v[108:111], a[160:163], v[236:239], v[108:111]
    ds_read_b64_tr_b16 a[236:237], v18 offset:6144
    v_mfma_f32_16x16x32_bf16 v[112:115], a[184:187], v[236:239], v[112:115]
    v_mfma_f32_16x16x32_bf16 v[116:119], a[208:211], v[236:239], v[116:119]
    ds_read_b64_tr_b16 a[238:239], v18 offset:12288
    v_mfma_f32_16x16x32_bf16 v[96:99], a[92:95], v[232:235], v[96:99]
    ds_read_b64_tr_b16 a[240:241], v18 offset:18432
    v_mfma_f32_16x16x32_bf16 v[100:103], a[116:119], v[232:235], v[100:103]
    v_mfma_f32_16x16x32_bf16 v[104:107], a[140:143], v[232:235], v[104:107]
    ds_read_b64_tr_b16 a[242:243], v18 offset:24576
    v_mfma_f32_16x16x32_bf16 v[108:111], a[164:167], v[232:235], v[108:111]
    v_mfma_f32_16x16x32_bf16 v[112:115], a[188:191], v[232:235], v[112:115]
    ds_read_b64_tr_b16 a[234:235], v18 offset:30720
    v_mfma_f32_16x16x32_bf16 v[116:119], a[212:215], v[232:235], v[116:119]
    s_add_i32 s50, s57, 0
    buffer_store_dwordx4 v[252:255], v249, s[16:19], s50 offen offset:0 sc1
    s_add_i32 s50, s57, 0
    buffer_store_dwordx4 a[36:39], v249, s[16:19], s50 offen offset:128 sc1
    s_add_i32 s50, s57, 0
    buffer_store_dwordx4 a[248:251], v249, s[16:19], s50 offen offset:256 sc1
    s_add_i32 s50, s57, 3072
    buffer_store_dwordx4 a[24:27], v248, s[16:19], s50 offen offset:0 sc1
    s_add_i32 s50, s57, 3072
    buffer_store_dwordx4 a[40:43], v248, s[16:19], s50 offen offset:128 sc1
    s_add_i32 s50, s57, 3072
    buffer_store_dwordx4 a[252:255], v248, s[16:19], s50 offen offset:256 sc1
    s_call_b64 s[94:95], F_sm1
    s_add_i32 s50, s57, 6144
    buffer_store_dwordx4 a[28:31], v248, s[16:19], s50 offen offset:0 sc1
    s_add_i32 s50, s57, 6144
    buffer_store_dwordx4 a[44:47], v248, s[16:19], s50 offen offset:128 sc1
    s_add_i32 s50, s57, 6144
    buffer_store_dwordx4 a[16:19], v248, s[16:19], s50 offen offset:256 sc1
    s_add_i32 s50, s57, 9216
    buffer_store_dwordx4 a[32:35], v248, s[16:19], s50 offen offset:0 sc1
    s_add_i32 s50, s57, 9216
    buffer_store_dwordx4 a[244:247], v248, s[16:19], s50 offen offset:128 sc1
    s_add_i32 s50, s57, 9216
    buffer_store_dwordx4 a[20:23], v248, s[16:19], s50 offen offset:256 sc1
    s_mov_b32 s56, 1
    s_add_i32 s57, s42, 12288
    s_call_b64 s[94:95], F_pv
    s_cmp_lg_u32 s61, 7
    s_cbranch_scc1 L_fin
    s_waitcnt vmcnt(12)
    v_max3_f32 v36, v72, v74, v76
    v_max3_f32 v36, v36, v78, v80
    v_max3_f32 v36, v36, v82, v84
    v_max_f32 v36, v36, v86
    v_sub_f32 v72, v72, v36
    v_sub_f32 v74, v74, v36
    v_sub_f32 v76, v76, v36
    v_sub_f32 v78, v78, v36
    v_sub_f32 v80, v80, v36
    v_sub_f32 v82, v82, v36
    v_sub_f32 v84, v84, v36
    v_sub_f32 v86, v86, v36
    v_exp_f32 v72, v72
    v_exp_f32 v74, v74
    v_exp_f32 v76, v76
    v_exp_f32 v78, v78
    v_exp_f32 v80, v80
    v_exp_f32 v82, v82
    v_exp_f32 v84, v84
    v_exp_f32 v86, v86
    v_mul_f32 v38, v72, v73
    v_fmac_f32 v38, v74, v75
    v_fmac_f32 v38, v76, v77
    v_fmac_f32 v38, v78, v79
    v_fmac_f32 v38, v80, v81
    v_fmac_f32 v38, v82, v83
    v_fmac_f32 v38, v84, v85
    v_fmac_f32 v38, v86, v87
    v_rcp_f32 v38, v38
    v_mul_f32 v120, v72, v192
    v_mul_f32 v121, v72, v193
    v_mul_f32 v122, v72, v194
    v_mul_f32 v123, v72, v195
    v_mul_f32 v124, v72, v196
    v_mul_f32 v125, v72, v197
    v_fmac_f32 v120, v74, v198
    v_fmac_f32 v121, v74, v199
    v_fmac_f32 v122, v74, v200
    v_fmac_f32 v123, v74, v201
    v_fmac_f32 v124, v74, v202
    v_fmac_f32 v125, v74, v203
    v_fmac_f32 v120, v76, v204
    v_fmac_f32 v121, v76, v205
    v_fmac_f32 v122, v76, v206
    v_fmac_f32 v123, v76, v207
    v_fmac_f32 v124, v76, v208
    v_fmac_f32 v125, v76, v209
    v_fmac_f32 v120, v78, v210
    v_fmac_f32 v121, v78, v211
    v_fmac_f32 v122, v78, v212
    v_fmac_f32 v123, v78, v213
    v_fmac_f32 v124, v78, v214
    v_fmac_f32 v125, v78, v215
    v_fmac_f32 v120, v80, v216
    v_fmac_f32 v121, v80, v217
    v_fmac_f32 v122, v80, v218
    v_fmac_f32 v123, v80, v219
    v_fmac_f32 v124, v80, v220
    v_fmac_f32 v125, v80, v221
    v_fmac_f32 v120, v82, v222
    v_fmac_f32 v121, v82, v223
    v_fmac_f32 v122, v82, v224
    v_fmac_f32 v123, v82, v225
    v_fmac_f32 v124, v82, v226
    v_fmac_f32 v125, v82, v227
    v_fmac_f32 v120, v84, v228
    v_fmac_f32 v121, v84, v229
    v_fmac_f32 v122, v84, v230
    v_fmac_f32 v123, v84, v231
    v_fmac_f32 v124, v84, v232
    v_fmac_f32 v125, v84, v233
    v_fmac_f32 v120, v86, v234
    v_fmac_f32 v121, v86, v235
    v_fmac_f32 v122, v86, v236
    v_fmac_f32 v123, v86, v237
    v_fmac_f32 v124, v86, v238
    v_fmac_f32 v125, v86, v239
    v_mul_f32 v120, v120, v38
    v_mul_f32 v121, v121, v38
    v_mul_f32 v122, v122, v38
    v_mul_f32 v123, v123, v38
    v_mul_f32 v124, v124, v38
    v_mul_f32 v125, v125, v38
    v_cvt_pk_bf16_f32 v120, v120, v121
    v_cvt_pk_bf16_f32 v121, v122, v123
    v_cvt_pk_bf16_f32 v122, v124, v125
    v_mul_u32_u24 v37, 12, v0
    buffer_store_dwordx3 v[120:122], v37, s[16:19], 0 offen sc1
L_fin:
L_end:
    s_endpgm
F_sm0:
    v_mov_b32 v123, 0
    v_max3_f32 v36, v72, v73, v74
    v_max3_f32 v38, v75, v76, v77
    v_max3_f32 v36, v36, v78, v79
    v_max3_f32 v38, v38, v80, v81
    v_max3_f32 v36, v36, v82, v83
    v_max3_f32 v38, v38, v84, v85
    v_max3_f32 v36, v36, v86, v87
    v_max3_f32 v38, v38, v88, v89
    v_max3_f32 v36, v36, v90, v91
    v_max3_f32 v38, v38, v92, v93
    v_max_f32 v36, v36, v38
    v_mov_b32 v37, v36
    s_nop 1
    v_permlane32_swap_b32 v36, v37
    v_max_f32 v36, v36, v37
    v_mov_b32 v37, v36
    s_nop 1
    v_permlane16_swap_b32 v36, v37
    v_max_f32 v36, v36, v37
    v_mul_f32 v36, s49, v36
    v_fma_f32 v72, v72, s49, -v36
    v_fma_f32 v73, v73, s49, -v36
    v_fma_f32 v74, v74, s49, -v36
    v_fma_f32 v75, v75, s49, -v36
    v_fma_f32 v76, v76, s49, -v36
    v_fma_f32 v77, v77, s49, -v36
    v_fma_f32 v78, v78, s49, -v36
    v_fma_f32 v79, v79, s49, -v36
    v_fma_f32 v80, v80, s49, -v36
    v_fma_f32 v81, v81, s49, -v36
    v_fma_f32 v82, v82, s49, -v36
    v_fma_f32 v83, v83, s49, -v36
    v_fma_f32 v84, v84, s49, -v36
    v_fma_f32 v85, v85, s49, -v36
    v_fma_f32 v86, v86, s49, -v36
    v_fma_f32 v87, v87, s49, -v36
    v_fma_f32 v88, v88, s49, -v36
    v_fma_f32 v89, v89, s49, -v36
    v_fma_f32 v90, v90, s49, -v36
    v_fma_f32 v91, v91, s49, -v36
    v_fma_f32 v92, v92, s49, -v36
    v_fma_f32 v93, v93, s49, -v36
    v_exp_f32 v72, v72
    v_exp_f32 v73, v73
    v_exp_f32 v74, v74
    v_exp_f32 v75, v75
    v_add_f32 v38, v72, v73
    v_exp_f32 v76, v76
    v_exp_f32 v77, v77
    v_add_f32 v39, v74, v75
    v_exp_f32 v78, v78
    v_add_f32 v38, v38, v76
    v_exp_f32 v79, v79
    v_add_f32 v39, v39, v77
    v_exp_f32 v80, v80
    v_add_f32 v38, v38, v78
    v_exp_f32 v81, v81
    v_add_f32 v39, v39, v79
    v_exp_f32 v82, v82
    v_add_f32 v38, v38, v80
    v_exp_f32 v83, v83
    v_add_f32 v39, v39, v81
    v_exp_f32 v84, v84
    v_add_f32 v38, v38, v82
    v_exp_f32 v85, v85
    v_add_f32 v39, v39, v83
    v_exp_f32 v86, v86
    v_add_f32 v38, v38, v84
    v_exp_f32 v87, v87
    v_add_f32 v39, v39, v85
    v_exp_f32 v88, v88
    v_add_f32 v38, v38, v86
    v_exp_f32 v89, v89
    v_add_f32 v39, v39, v87
    v_exp_f32 v90, v90
    v_add_f32 v38, v38, v88
    v_exp_f32 v91, v91
    v_add_f32 v39, v39, v89
    v_exp_f32 v92, v92
    v_add_f32 v38, v38, v90
    v_exp_f32 v93, v93
    v_add_f32 v39, v39, v91
    v_add_f32 v38, v38, v92
    v_add_f32 v39, v39, v93
    v_add_f32 v38, v38, v39
    v_mov_b32 v37, v38
    s_nop 1
    v_permlane32_swap_b32 v38, v37
    v_add_f32 v38, v38, v37
    v_mov_b32 v37, v38
    s_nop 1
    v_permlane16_swap_b32 v38, v37
    v_add_f32 v38, v38, v37
    v_rcp_f32 v38, v38
    s_nop 0
    v_mul_f32 v72, v72, v38
    v_mul_f32 v73, v73, v38
    v_mul_f32 v74, v74, v38
    v_mul_f32 v75, v75, v38
    v_cvt_pk_bf16_f32 v120, v72, v73
    v_mul_f32 v76, v76, v38
    v_mul_f32 v77, v77, v38
    v_cvt_pk_bf16_f32 v121, v74, v75
    v_mul_f32 v78, v78, v38
    v_mul_f32 v79, v79, v38
    v_cvt_pk_bf16_f32 v124, v76, v77
    v_mul_f32 v80, v80, v38
    v_mul_f32 v81, v81, v38
    v_cvt_pk_bf16_f32 v125, v78, v79
    v_mul_f32 v82, v82, v38
    v_mul_f32 v83, v83, v38
    v_cvt_pk_bf16_f32 v126, v80, v81
    v_mul_f32 v84, v84, v38
    v_mul_f32 v85, v85, v38
    v_cvt_pk_bf16_f32 v127, v82, v83
    v_mul_f32 v86, v86, v38
    v_mul_f32 v87, v87, v38
    v_cvt_pk_bf16_f32 v128, v84, v85
    v_mul_f32 v88, v88, v38
    v_mul_f32 v89, v89, v38
    v_cvt_pk_bf16_f32 v129, v86, v87
    v_mul_f32 v90, v90, v38
    v_mul_f32 v91, v91, v38
    v_cvt_pk_bf16_f32 v130, v88, v89
    v_mul_f32 v92, v92, v38
    v_mul_f32 v93, v93, v38
    v_cvt_pk_bf16_f32 v131, v90, v91
    v_cvt_pk_bf16_f32 v122, v92, v93
    s_setpc_b64 s[94:95]
F_sm1:
    v_mov_b32 v141, 0
    v_max3_f32 v36, v96, v97, v98
    v_max3_f32 v38, v99, v100, v101
    v_max3_f32 v36, v36, v102, v103
    v_max3_f32 v38, v38, v104, v105
    v_max3_f32 v36, v36, v106, v107
    v_max3_f32 v38, v38, v108, v109
    v_max3_f32 v36, v36, v110, v111
    v_max3_f32 v38, v38, v112, v113
    v_max3_f32 v36, v36, v114, v115
    v_max3_f32 v38, v38, v116, v117
    v_max_f32 v36, v36, v38
    v_mov_b32 v37, v36
    s_nop 1
    v_permlane32_swap_b32 v36, v37
    v_max_f32 v36, v36, v37
    v_mov_b32 v37, v36
    s_nop 1
    v_permlane16_swap_b32 v36, v37
    v_max_f32 v36, v36, v37
    v_mul_f32 v36, s49, v36
    v_fma_f32 v96, v96, s49, -v36
    v_fma_f32 v97, v97, s49, -v36
    v_fma_f32 v98, v98, s49, -v36
    v_fma_f32 v99, v99, s49, -v36
    v_fma_f32 v100, v100, s49, -v36
    v_fma_f32 v101, v101, s49, -v36
    v_fma_f32 v102, v102, s49, -v36
    v_fma_f32 v103, v103, s49, -v36
    v_fma_f32 v104, v104, s49, -v36
    v_fma_f32 v105, v105, s49, -v36
    v_fma_f32 v106, v106, s49, -v36
    v_fma_f32 v107, v107, s49, -v36
    v_fma_f32 v108, v108, s49, -v36
    v_fma_f32 v109, v109, s49, -v36
    v_fma_f32 v110, v110, s49, -v36
    v_fma_f32 v111, v111, s49, -v36
    v_fma_f32 v112, v112, s49, -v36
    v_fma_f32 v113, v113, s49, -v36
    v_fma_f32 v114, v114, s49, -v36
    v_fma_f32 v115, v115, s49, -v36
    v_fma_f32 v116, v116, s49, -v36
    v_fma_f32 v117, v117, s49, -v36
    v_exp_f32 v96, v96
    v_exp_f32 v97, v97
    v_exp_f32 v98, v98
    v_exp_f32 v99, v99
    v_add_f32 v38, v96, v97
    v_exp_f32 v100, v100
    v_exp_f32 v101, v101
    v_add_f32 v39, v98, v99
    v_exp_f32 v102, v102
    v_add_f32 v38, v38, v100
    v_exp_f32 v103, v103
    v_add_f32 v39, v39, v101
    v_exp_f32 v104, v104
    v_add_f32 v38, v38, v102
    v_exp_f32 v105, v105
    v_add_f32 v39, v39, v103
    v_exp_f32 v106, v106
    v_add_f32 v38, v38, v104
    v_exp_f32 v107, v107
    v_add_f32 v39, v39, v105
    v_exp_f32 v108, v108
    v_add_f32 v38, v38, v106
    v_exp_f32 v109, v109
    v_add_f32 v39, v39, v107
    v_exp_f32 v110, v110
    v_add_f32 v38, v38, v108
    v_exp_f32 v111, v111
    v_add_f32 v39, v39, v109
    v_exp_f32 v112, v112
    v_add_f32 v38, v38, v110
    v_exp_f32 v113, v113
    v_add_f32 v39, v39, v111
    v_exp_f32 v114, v114
    v_add_f32 v38, v38, v112
    v_exp_f32 v115, v115
    v_add_f32 v39, v39, v113
    v_exp_f32 v116, v116
    v_add_f32 v38, v38, v114
    v_exp_f32 v117, v117
    v_add_f32 v39, v39, v115
    v_add_f32 v38, v38, v116
    v_add_f32 v39, v39, v117
    v_add_f32 v38, v38, v39
    v_mov_b32 v37, v38
    s_nop 1
    v_permlane32_swap_b32 v38, v37
    v_add_f32 v38, v38, v37
    v_mov_b32 v37, v38
    s_nop 1
    v_permlane16_swap_b32 v38, v37
    v_add_f32 v38, v38, v37
    v_rcp_f32 v38, v38
    s_nop 0
    v_mul_f32 v96, v96, v38
    v_mul_f32 v97, v97, v38
    v_mul_f32 v98, v98, v38
    v_mul_f32 v99, v99, v38
    v_cvt_pk_bf16_f32 v132, v96, v97
    v_mul_f32 v100, v100, v38
    v_mul_f32 v101, v101, v38
    v_cvt_pk_bf16_f32 v133, v98, v99
    v_mul_f32 v102, v102, v38
    v_mul_f32 v103, v103, v38
    v_cvt_pk_bf16_f32 v134, v100, v101
    v_mul_f32 v104, v104, v38
    v_mul_f32 v105, v105, v38
    v_cvt_pk_bf16_f32 v135, v102, v103
    v_mul_f32 v106, v106, v38
    v_mul_f32 v107, v107, v38
    v_cvt_pk_bf16_f32 v136, v104, v105
    v_mul_f32 v108, v108, v38
    v_mul_f32 v109, v109, v38
    v_cvt_pk_bf16_f32 v137, v106, v107
    v_mul_f32 v110, v110, v38
    v_mul_f32 v111, v111, v38
    v_cvt_pk_bf16_f32 v138, v108, v109
    v_mul_f32 v112, v112, v38
    v_mul_f32 v113, v113, v38
    v_cvt_pk_bf16_f32 v139, v110, v111
    v_mul_f32 v114, v114, v38
    v_mul_f32 v115, v115, v38
    v_cvt_pk_bf16_f32 v142, v112, v113
    v_mul_f32 v116, v116, v38
    v_mul_f32 v117, v117, v38
    v_cvt_pk_bf16_f32 v143, v114, v115
    v_cvt_pk_bf16_f32 v140, v116, v117
    s_setpc_b64 s[94:95]
F_pv:
    s_waitcnt lgkmcnt(14)
    v_mfma_f32_16x16x32_bf16 v[144:147], v[176:179], v[120:123], 0
    ds_read_b64_tr_b16 a[0:1], v19 offset:0
    ds_read_b64_tr_b16 a[2:3], v20 offset:8288
    v_mfma_f32_16x16x32_bf16 v[148:151], v[182:185], v[132:135], 0
    ds_read_b64_tr_b16 a[6:7], v19 offset:6144
    v_mfma_f32_16x16x32_bf16 v[144:147], v[182:185], v[124:127], v[144:147]
    ds_read_b64_tr_b16 a[8:9], v19 offset:12288
    v_mfma_f32_16x16x32_bf16 v[148:151], v[186:189], v[136:139], v[148:151]
    ds_read_b64_tr_b16 a[10:11], v19 offset:18432
    v_mfma_f32_16x16x32_bf16 v[144:147], v[186:189], v[128:131], v[144:147]
    ds_read_b64_tr_b16 a[12:13], v19 offset:24576
    v_mfma_f32_16x16x32_bf16 v[148:151], v[178:181], v[140:143], v[148:151]
    ds_read_b64_tr_b16 a[4:5], v19 offset:30720
    s_waitcnt lgkmcnt(14)
    v_mfma_f32_16x16x32_bf16 v[152:155], a[216:219], v[120:123], 0
    ds_read_b64_tr_b16 v[176:177], v16 offset:1024
    ds_read_b64_tr_b16 v[178:179], v20 offset:8320
    v_mfma_f32_16x16x32_bf16 v[156:159], a[222:225], v[132:135], 0
    ds_read_b64_tr_b16 v[182:183], v16 offset:7168
    v_mfma_f32_16x16x32_bf16 v[152:155], a[222:225], v[124:127], v[152:155]
    ds_read_b64_tr_b16 v[184:185], v16 offset:13312
    v_mfma_f32_16x16x32_bf16 v[156:159], a[226:229], v[136:139], v[156:159]
    ds_read_b64_tr_b16 v[186:187], v16 offset:19456
    v_mfma_f32_16x16x32_bf16 v[152:155], a[226:229], v[128:131], v[152:155]
    ds_read_b64_tr_b16 v[188:189], v16 offset:25600
    v_mfma_f32_16x16x32_bf16 v[156:159], a[218:221], v[140:143], v[156:159]
    ds_read_b64_tr_b16 v[180:181], v16 offset:31744
    s_waitcnt lgkmcnt(14)
    v_mfma_f32_16x16x32_bf16 v[160:163], a[230:233], v[120:123], 0
    ds_read_b64_tr_b16 a[216:217], v17 offset:1024
    ds_read_b64_tr_b16 a[218:219], v20 offset:8352
    v_cvt_pk_bf16_f32 v144, v144, v145
    v_mfma_f32_16x16x32_bf16 v[164:167], a[236:239], v[132:135], 0
    ds_read_b64_tr_b16 a[222:223], v17 offset:7168
    v_cvt_pk_bf16_f32 v145, v146, v147
    v_mfma_f32_16x16x32_bf16 v[160:163], a[236:239], v[124:127], v[160:163]
    ds_read_b64_tr_b16 a[224:225], v17 offset:13312
    v_mfma_f32_16x16x32_bf16 v[164:167], a[240:243], v[136:139], v[164:167]
    ds_read_b64_tr_b16 a[226:227], v17 offset:19456
    v_cvt_pk_bf16_f32 v148, v148, v149
    v_mfma_f32_16x16x32_bf16 v[160:163], a[240:243], v[128:131], v[160:163]
    ds_read_b64_tr_b16 a[228:229], v17 offset:25600
    v_cvt_pk_bf16_f32 v149, v150, v151
    v_mfma_f32_16x16x32_bf16 v[164:167], a[232:235], v[140:143], v[164:167]
    ds_read_b64_tr_b16 a[220:221], v17 offset:31744
    s_cmp_lg_u32 s61, 3
    s_cbranch_scc1 L_notlast
    s_waitcnt vmcnt(12)
    v_readfirstlane_b32 s61, v28
    s_nop 0
    s_cmp_lg_u32 s61, 7
    s_cbranch_scc1 L_notlast
    v_lshrrev_b32 v40, 5, v0
    v_and_b32 v41, 31, v0
    v_mul_u32_u24 v41, 24, v41
    v_mul_u32_u24 v42, 768, v40
    v_add_u32 v41, v41, v42
    v_lshlrev_b32 v40, 6, v40
    s_mov_b32 s50, 12288
    buffer_load_dwordx4 v[72:75], v40, s[20:23], s50 offen offset:0 sc1
    buffer_load_dwordx4 v[76:79], v40, s[20:23], s50 offen offset:16 sc1
    buffer_load_dwordx4 v[80:83], v40, s[20:23], s50 offen offset:32 sc1
    buffer_load_dwordx4 v[84:87], v40, s[20:23], s50 offen offset:48 sc1
    s_mov_b32 s50, 0
    buffer_load_dwordx4 v[192:195], v41, s[20:23], s50 offen sc1
    buffer_load_dwordx2 v[196:197], v41, s[20:23], s50 offen offset:16 sc1
    s_mov_b32 s50, 1536
    buffer_load_dwordx4 v[198:201], v41, s[20:23], s50 offen sc1
    buffer_load_dwordx2 v[202:203], v41, s[20:23], s50 offen offset:16 sc1
    s_mov_b32 s50, 3072
    buffer_load_dwordx4 v[204:207], v41, s[20:23], s50 offen sc1
    buffer_load_dwordx2 v[208:209], v41, s[20:23], s50 offen offset:16 sc1
    s_mov_b32 s50, 4608
    buffer_load_dwordx4 v[210:213], v41, s[20:23], s50 offen sc1
    buffer_load_dwordx2 v[214:215], v41, s[20:23], s50 offen offset:16 sc1
    s_mov_b32 s50, 6144
    buffer_load_dwordx4 v[216:219], v41, s[20:23], s50 offen sc1
    buffer_load_dwordx2 v[220:221], v41, s[20:23], s50 offen offset:16 sc1
    s_mov_b32 s50, 7680
    buffer_load_dwordx4 v[222:225], v41, s[20:23], s50 offen sc1
    buffer_load_dwordx2 v[226:227], v41, s[20:23], s50 offen offset:16 sc1
    s_mov_b32 s50, 9216
    buffer_load_dwordx4 v[228:231], v41, s[20:23], s50 offen sc1
    buffer_load_dwordx2 v[232:233], v41, s[20:23], s50 offen offset:16 sc1
    s_mov_b32 s50, 10752
    buffer_load_dwordx4 v[234:237], v41, s[20:23], s50 offen sc1
    buffer_load_dwordx2 v[238:239], v41, s[20:23], s50 offen offset:16 sc1
L_notlast:
    s_waitcnt lgkmcnt(14)
    v_mfma_f32_16x16x32_bf16 v[168:171], a[0:3], v[120:123], 0
    ds_read_b64_tr_b16 a[230:231], v18 offset:1024
    ds_write_b64 v9, v[144:145] offset:0
    v_cvt_pk_bf16_f32 v152, v152, v153
    v_mfma_f32_16x16x32_bf16 v[172:175], a[6:9], v[132:135], 0
    ds_read_b64_tr_b16 a[232:233], v20 offset:8384
    v_cvt_pk_bf16_f32 v153, v154, v155
    v_mfma_f32_16x16x32_bf16 v[168:171], a[6:9], v[124:127], v[168:171]
    ds_write_b64 v9, v[148:149] offset:2048
    ds_read_b64_tr_b16 a[236:237], v18 offset:7168
    v_mfma_f32_16x16x32_bf16 v[172:175], a[10:13], v[136:139], v[172:175]
    ds_read_b64_tr_b16 a[238:239], v18 offset:13312
    v_cvt_pk_bf16_f32 v156, v156, v157
    v_mfma_f32_16x16x32_bf16 v[168:171], a[10:13], v[128:131], v[168:171]
    ds_read_b64_tr_b16 a[240:241], v18 offset:19456
    ds_read_b64_tr_b16 a[242:243], v18 offset:25600
    v_cvt_pk_bf16_f32 v157, v158, v159
    v_mfma_f32_16x16x32_bf16 v[172:175], a[2:5], v[140:143], v[172:175]
    ds_read_b64_tr_b16 a[234:235], v18 offset:31744
    s_waitcnt lgkmcnt(15)
    v_mfma_f32_16x16x32_bf16 v[144:147], v[176:179], v[120:123], 0
    ds_read_b64_tr_b16 a[0:1], v19 offset:1024
    ds_write_b64 v10, v[152:153] offset:0
    v_cvt_pk_bf16_f32 v160, v160, v161
    v_mfma_f32_16x16x32_bf16 v[148:151], v[182:185], v[132:135], 0
    ds_read_b64_tr_b16 a[2:3], v20 offset:8416
    v_cvt_pk_bf16_f32 v161, v162, v163
    v_mfma_f32_16x16x32_bf16 v[144:147], v[182:185], v[124:127], v[144:147]
    ds_write_b64 v10, v[156:157] offset:2048
    ds_read_b64_tr_b16 a[6:7], v19 offset:7168
    v_mfma_f32_16x16x32_bf16 v[148:151], v[186:189], v[136:139], v[148:151]
    ds_read_b64_tr_b16 a[8:9], v19 offset:13312
    v_cvt_pk_bf16_f32 v164, v164, v165
    v_mfma_f32_16x16x32_bf16 v[144:147], v[186:189], v[128:131], v[144:147]
    ds_read_b64_tr_b16 a[10:11], v19 offset:19456
    ds_read_b64_tr_b16 a[12:13], v19 offset:25600
    v_cvt_pk_bf16_f32 v165, v166, v167
    v_mfma_f32_16x16x32_bf16 v[148:151], v[178:181], v[140:143], v[148:151]
    ds_read_b64_tr_b16 a[4:5], v19 offset:31744
    s_cmp_lg_u32 s56, 0
    s_cbranch_scc1 L_nosync
    s_add_i32 s44, s42, 12288
    buffer_load_dwordx4 v[192:195], v14, s[4:7], s44 offen offset:0 nt
    buffer_load_dwordx4 v[196:199], v15, s[4:7], s44 offen offset:0 nt
    buffer_load_dwordx4 v[200:203], v14, s[4:7], s44 offen offset:128 nt
    buffer_load_dwordx4 v[204:207], v15, s[4:7], s44 offen offset:128 nt
    buffer_load_dwordx4 v[208:211], v14, s[4:7], s44 offen offset:256 nt
    buffer_load_dwordx4 v[212:215], v15, s[4:7], s44 offen offset:256 nt
    s_add_i32 s44, s42, 18432
    buffer_load_dwordx4 v[220:223], v14, s[4:7], s44 offen offset:0 nt
    buffer_load_dwordx4 v[224:227], v15, s[4:7], s44 offen offset:0 nt
    buffer_load_dwordx4 v[228:231], v14, s[4:7], s44 offen offset:128 nt
    buffer_load_dwordx4 v[232:235], v15, s[4:7], s44 offen offset:128 nt
    buffer_load_dwordx4 v[236:239], v14, s[4:7], s44 offen offset:256 nt
    buffer_load_dwordx4 v[240:243], v15, s[4:7], s44 offen offset:256 nt
    s_waitcnt vmcnt(12)
    s_barrier
L_nosync:
    s_waitcnt lgkmcnt(15)
    v_mfma_f32_16x16x32_bf16 v[152:155], a[216:219], v[120:123], 0
    ds_read_b64_tr_b16 v[176:177], v16 offset:2048
    ds_write_b64 v11, v[160:161] offset:0
    v_cvt_pk_bf16_f32 v168, v168, v169
    v_mfma_f32_16x16x32_bf16 v[156:159], a[222:225], v[132:135], 0
    ds_read_b64_tr_b16 v[178:179], v20 offset:8448
    v_cvt_pk_bf16_f32 v169, v170, v171
    v_mfma_f32_16x16x32_bf16 v[152:155], a[222:225], v[124:127], v[152:155]
    ds_write_b64 v11, v[164:165] offset:2048
    ds_read_b64_tr_b16 v[182:183], v16 offset:8192
    v_mfma_f32_16x16x32_bf16 v[156:159], a[226:229], v[136:139], v[156:159]
    ds_read_b64_tr_b16 v[184:185], v16 offset:14336
    v_cvt_pk_bf16_f32 v172, v172, v173
    v_mfma_f32_16x16x32_bf16 v[152:155], a[226:229], v[128:131], v[152:155]
    ds_read_b64_tr_b16 v[186:187], v16 offset:20480
    ds_read_b64_tr_b16 v[188:189], v16 offset:26624
    v_cvt_pk_bf16_f32 v173, v174, v175
    v_mfma_f32_16x16x32_bf16 v[156:159], a[218:221], v[140:143], v[156:159]
    ds_read_b64_tr_b16 v[180:181], v16 offset:32768
    s_waitcnt lgkmcnt(15)
    v_mfma_f32_16x16x32_bf16 v[160:163], a[230:233], v[120:123], 0
    ds_read_b64_tr_b16 a[216:217], v17 offset:2048
    ds_write_b64 v12, v[168:169] offset:0
    ds_read_b64_tr_b16 a[218:219], v20 offset:8480
    v_cvt_pk_bf16_f32 v144, v144, v145
    v_mfma_f32_16x16x32_bf16 v[164:167], a[236:239], v[132:135], 0
    ds_write_b64 v12, v[172:173] offset:2048
    ds_read_b64_tr_b16 a[222:223], v17 offset:8192
    v_cvt_pk_bf16_f32 v145, v146, v147
    v_mfma_f32_16x16x32_bf16 v[160:163], a[236:239], v[124:127], v[160:163]
    ds_read_b128 v[252:255], v13 offset:0
    ds_read_b64_tr_b16 a[224:225], v17 offset:14336
    v_mfma_f32_16x16x32_bf16 v[164:167], a[240:243], v[136:139], v[164:167]
    ds_read_b128 a[24:27], v13 offset:1024
    ds_read_b64_tr_b16 a[226:227], v17 offset:20480
    v_cvt_pk_bf16_f32 v148, v148, v149
    v_mfma_f32_16x16x32_bf16 v[160:163], a[240:243], v[128:131], v[160:163]
    ds_read_b128 a[28:31], v13 offset:2048
    ds_read_b64_tr_b16 a[228:229], v17 offset:26624
    v_cvt_pk_bf16_f32 v149, v150, v151
    v_mfma_f32_16x16x32_bf16 v[164:167], a[232:235], v[140:143], v[164:167]
    ds_read_b128 a[32:35], v13 offset:3072
    ds_read_b64_tr_b16 a[220:221], v17 offset:32768
    s_waitcnt lgkmcnt(15)
    v_mfma_f32_16x16x32_bf16 v[168:171], a[0:3], v[120:123], 0
    ds_read_b64_tr_b16 a[230:231], v18 offset:2048
    ds_write_b64 v9, v[144:145] offset:0
    v_cvt_pk_bf16_f32 v152, v152, v153
    v_mfma_f32_16x16x32_bf16 v[172:175], a[6:9], v[132:135], 0
    ds_read_b64_tr_b16 a[232:233], v20 offset:8512
    v_cvt_pk_bf16_f32 v153, v154, v155
    v_mfma_f32_16x16x32_bf16 v[168:171], a[6:9], v[124:127], v[168:171]
    ds_write_b64 v9, v[148:149] offset:2048
    ds_read_b64_tr_b16 a[236:237], v18 offset:8192
    v_mfma_f32_16x16x32_bf16 v[172:175], a[10:13], v[136:139], v[172:175]
    ds_read_b64_tr_b16 a[238:239], v18 offset:14336
    v_cvt_pk_bf16_f32 v156, v156, v157
    v_mfma_f32_16x16x32_bf16 v[168:171], a[10:13], v[128:131], v[168:171]
    ds_read_b64_tr_b16 a[240:241], v18 offset:20480
    ds_read_b64_tr_b16 a[242:243], v18 offset:26624
    v_cvt_pk_bf16_f32 v157, v158, v159
    v_mfma_f32_16x16x32_bf16 v[172:175], a[2:5], v[140:143], v[172:175]
    ds_read_b64_tr_b16 a[234:235], v18 offset:32768
    s_cmp_eq_u32 s56, 0
    s_cbranch_scc1 L_hold0
    s_add_i32 s50, s57, 0
    s_waitcnt lgkmcnt(15)
    buffer_store_dwordx4 v[252:255], v248, s[16:19], s50 offen offset:0 sc1
    s_add_i32 s50, s57, 3072
    s_waitcnt lgkmcnt(14)
    buffer_store_dwordx4 a[24:27], v248, s[16:19], s50 offen offset:0 sc1
    s_add_i32 s50, s57, 6144
    s_waitcnt lgkmcnt(12)
    buffer_store_dwordx4 a[28:31], v248, s[16:19], s50 offen offset:0 sc1
    s_add_i32 s50, s57, 9216
    s_waitcnt lgkmcnt(10)
    buffer_store_dwordx4 a[32:35], v248, s[16:19], s50 offen offset:0 sc1
L_hold0:
    s_waitcnt lgkmcnt(15)
    v_mfma_f32_16x16x32_bf16 v[144:147], v[176:179], v[120:123], 0
    ds_read_b64_tr_b16 a[0:1], v19 offset:2048
    ds_write_b64 v10, v[152:153] offset:0
    v_cvt_pk_bf16_f32 v160, v160, v161
    v_mfma_f32_16x16x32_bf16 v[148:151], v[182:185], v[132:135], 0
    ds_read_b64_tr_b16 a[2:3], v20 offset:8544
    v_cvt_pk_bf16_f32 v161, v162, v163
    v_mfma_f32_16x16x32_bf16 v[144:147], v[182:185], v[124:127], v[144:147]
    ds_write_b64 v10, v[156:157] offset:2048
    ds_read_b64_tr_b16 a[6:7], v19 offset:8192
    v_mfma_f32_16x16x32_bf16 v[148:151], v[186:189], v[136:139], v[148:151]
    ds_read_b64_tr_b16 a[8:9], v19 offset:14336
    v_cvt_pk_bf16_f32 v164, v164, v165
    v_mfma_f32_16x16x32_bf16 v[144:147], v[186:189], v[128:131], v[144:147]
    ds_read_b64_tr_b16 a[10:11], v19 offset:20480
    ds_read_b64_tr_b16 a[12:13], v19 offset:26624
    v_cvt_pk_bf16_f32 v165, v166, v167
    v_mfma_f32_16x16x32_bf16 v[148:151], v[178:181], v[140:143], v[148:151]
    ds_read_b64_tr_b16 a[4:5], v19 offset:32768
    s_waitcnt lgkmcnt(15)
    v_mfma_f32_16x16x32_bf16 v[152:155], a[216:219], v[120:123], 0
    ds_write_b64 v11, v[160:161] offset:0
    v_cvt_pk_bf16_f32 v168, v168, v169
    v_mfma_f32_16x16x32_bf16 v[156:159], a[222:225], v[132:135], 0
    v_cvt_pk_bf16_f32 v169, v170, v171
    v_mfma_f32_16x16x32_bf16 v[152:155], a[222:225], v[124:127], v[152:155]
    v_mfma_f32_16x16x32_bf16 v[156:159], a[226:229], v[136:139], v[156:159]
    ds_write_b64 v11, v[164:165] offset:2048
    v_cvt_pk_bf16_f32 v172, v172, v173
    v_mfma_f32_16x16x32_bf16 v[152:155], a[226:229], v[128:131], v[152:155]
    v_cvt_pk_bf16_f32 v173, v174, v175
    v_mfma_f32_16x16x32_bf16 v[156:159], a[218:221], v[140:143], v[156:159]
    s_waitcnt lgkmcnt(11)
    v_mfma_f32_16x16x32_bf16 v[160:163], a[230:233], v[120:123], 0
    ds_write_b64 v12, v[168:169] offset:0
    v_cvt_pk_bf16_f32 v144, v144, v145
    v_mfma_f32_16x16x32_bf16 v[164:167], a[236:239], v[132:135], 0
    ds_write_b64 v12, v[172:173] offset:2048
    v_cvt_pk_bf16_f32 v145, v146, v147
    v_mfma_f32_16x16x32_bf16 v[160:163], a[236:239], v[124:127], v[160:163]
    ds_read_b128 a[36:39], v13 offset:0
    v_mfma_f32_16x16x32_bf16 v[164:167], a[240:243], v[136:139], v[164:167]
    ds_read_b128 a[40:43], v13 offset:1024
    v_cvt_pk_bf16_f32 v148, v148, v149
    v_mfma_f32_16x16x32_bf16 v[160:163], a[240:243], v[128:131], v[160:163]
    ds_read_b128 a[44:47], v13 offset:2048
    v_cvt_pk_bf16_f32 v149, v150, v151
    v_mfma_f32_16x16x32_bf16 v[164:167], a[232:235], v[140:143], v[164:167]
    ds_read_b128 a[244:247], v13 offset:3072
    s_waitcnt lgkmcnt(8)
    v_mfma_f32_16x16x32_bf16 v[168:171], a[0:3], v[120:123], 0
    ds_write_b64 v9, v[144:145] offset:0
    v_cvt_pk_bf16_f32 v152, v152, v153
    v_mfma_f32_16x16x32_bf16 v[172:175], a[6:9], v[132:135], 0
    v_cvt_pk_bf16_f32 v153, v154, v155
    v_mfma_f32_16x16x32_bf16 v[168:171], a[6:9], v[124:127], v[168:171]
    v_mfma_f32_16x16x32_bf16 v[172:175], a[10:13], v[136:139], v[172:175]
    ds_write_b64 v9, v[148:149] offset:2048
    v_cvt_pk_bf16_f32 v156, v156, v157
    v_mfma_f32_16x16x32_bf16 v[168:171], a[10:13], v[128:131], v[168:171]
    v_cvt_pk_bf16_f32 v157, v158, v159
    v_mfma_f32_16x16x32_bf16 v[172:175], a[2:5], v[140:143], v[172:175]
    s_cmp_eq_u32 s56, 0
    s_cbranch_scc1 L_hold1
    s_add_i32 s50, s57, 0
    s_waitcnt lgkmcnt(5)
    buffer_store_dwordx4 a[36:39], v248, s[16:19], s50 offen offset:128 sc1
    s_add_i32 s50, s57, 3072
    s_waitcnt lgkmcnt(4)
    buffer_store_dwordx4 a[40:43], v248, s[16:19], s50 offen offset:128 sc1
    s_add_i32 s50, s57, 6144
    s_waitcnt lgkmcnt(3)
    buffer_store_dwordx4 a[44:47], v248, s[16:19], s50 offen offset:128 sc1
    s_add_i32 s50, s57, 9216
    s_waitcnt lgkmcnt(2)
    buffer_store_dwordx4 a[244:247], v248, s[16:19], s50 offen offset:128 sc1
L_hold1:
    ds_write_b64 v10, v[152:153] offset:0
    ds_write_b64 v10, v[156:157] offset:2048
    v_cvt_pk_bf16_f32 v160, v160, v161
    v_cvt_pk_bf16_f32 v161, v162, v163
    v_cvt_pk_bf16_f32 v164, v164, v165
    v_cvt_pk_bf16_f32 v165, v166, v167
    v_cvt_pk_bf16_f32 v168, v168, v169
    v_cvt_pk_bf16_f32 v169, v170, v171
    v_cvt_pk_bf16_f32 v172, v172, v173
    v_cvt_pk_bf16_f32 v173, v174, v175
    ds_write_b64 v11, v[160:161] offset:0
    ds_write_b64 v11, v[164:165] offset:2048
    ds_write_b64 v12, v[168:169] offset:0
    ds_write_b64 v12, v[172:173] offset:2048
    ds_read_b128 a[248:251], v13 offset:0
    ds_read_b128 a[252:255], v13 offset:1024
    ds_read_b128 a[16:19], v13 offset:2048
    ds_read_b128 a[20:23], v13 offset:3072
    s_cmp_eq_u32 s56, 0
    s_cbranch_scc1 L_hold2
    s_add_i32 s50, s57, 0
    s_waitcnt lgkmcnt(3)
    buffer_store_dwordx4 a[248:251], v248, s[16:19], s50 offen offset:256 sc1
    s_add_i32 s50, s57, 3072
    s_waitcnt lgkmcnt(2)
    buffer_store_dwordx4 a[252:255], v248, s[16:19], s50 offen offset:256 sc1
    s_add_i32 s50, s57, 6144
    s_waitcnt lgkmcnt(1)
    buffer_store_dwordx4 a[16:19], v248, s[16:19], s50 offen offset:256 sc1
    s_add_i32 s50, s57, 9216
    s_waitcnt lgkmcnt(0)
    buffer_store_dwordx4 a[20:23], v248, s[16:19], s50 offen offset:256 sc1
L_hold2:
    s_setpc_b64 s[94:95]
L_codeend:
    .fill 64, 4, 0xbf810000

.section .rodata,"a"
.p2align 6
.amdhsa_kernel standalone__global_local_windowed_global_tokens__prompt_kernel
  .amdhsa_next_free_vgpr 512
  .amdhsa_next_free_sgpr 96
  .amdhsa_accum_offset 256
  .amdhsa_group_segment_fixed_size 0
  .amdhsa_kernarg_size 64
  .amdhsa_user_sgpr_count 2
  .amdhsa_user_sgpr_kernarg_segment_ptr 1
  .amdhsa_system_sgpr_workgroup_id_x 1
  .amdhsa_float_denorm_mode_32 3
.end_amdhsa_kernel
```
